```python
import torch

def _softmax(x, axis=-1):
    return torch.softmax(x, dim=axis)
def _gelu(x):
    return torch.nn.functional.gelu(x, approximate="tanh")
def _silu(x):
    return torch.nn.functional.silu(x)
def _sigmoid(x):
    return torch.sigmoid(x)
def _layernorm(x, axis=-1, eps=1e-5):
    m = x.mean(dim=axis, keepdim=True)
    v = x.var(dim=axis, keepdim=True, unbiased=False)
    return (x - m) / torch.sqrt(v + eps)
def _scatter_add(tgt, idx, src, axis=0):
    return tgt.clone().index_add_(axis, idx, src)
def _segment_sum(src, seg, n):
    out = torch.zeros((n,) + src.shape[1:], dtype=src.dtype)
    return out.index_add_(0, seg, src)
def _pad(x, pw):
    flat = tuple(v for pair in reversed(pw) for v in pair)
    return torch.nn.functional.pad(x, flat)

kernel_name = 'interleave_layers__sliding_block_cached__sliding_block_cached__decode'

def setup_inputs():

    _w = (lambda a: (lambda t: t.to(torch.bfloat16) if t.is_floating_point() else t)(torch.as_tensor(a)))
    def _A_setup():
        B, Sq, D = 2, 1, 576
        Hq, Hkv, Sk, Dh = 32, 16, 4096, 128
        assert Hq % Hkv == 0, (Hq, Hkv)
        return {
            "x": _w((lambda *s: torch.randn(*s, dtype=torch.bfloat16) * 0.05)(B, Sq, D)),
            "k_cache": _w((lambda *s: torch.randn(*s, dtype=torch.bfloat16) * 0.8)(B, Hkv, Sk, Dh)),
            "v_cache": _w((lambda *s: torch.randn(*s, dtype=torch.bfloat16) * 1.6)(B, Hkv, Sk, Dh)),
            "wq": _w((lambda *s: torch.randn(*s, dtype=torch.bfloat16) * 0.8)(D, Hq * Dh) * (D ** -0.5)),
            "wo": _w((lambda *s: torch.randn(*s, dtype=torch.bfloat16) * 1.6)(Hq * Dh, D) * ((Hq * Dh) ** -0.5)),
        }
    _A_in = _A_setup()

    def _B_setup():
        B, Sq, D = 2, 1, 576
        Hq, Hkv, Sk, Dh = 32, 16, 4096, 128
        assert Hq % Hkv == 0, (Hq, Hkv)
        return {
            "x": _w((lambda *s: torch.randn(*s, dtype=torch.bfloat16) * 0.05)(B, Sq, D)),
            "k_cache": _w((lambda *s: torch.randn(*s, dtype=torch.bfloat16) * 3.2)(B, Hkv, Sk, Dh)),
            "v_cache": _w((lambda *s: torch.randn(*s, dtype=torch.bfloat16) * 0.4)(B, Hkv, Sk, Dh)),
            "wq": _w((lambda *s: torch.randn(*s, dtype=torch.bfloat16) * 3.2)(D, Hq * Dh) * (D ** -0.5)),
            "wo": _w((lambda *s: torch.randn(*s, dtype=torch.bfloat16) * 0.4)(Hq * Dh, D) * ((Hq * Dh) ** -0.5)),
        }
    _B_in = _B_setup()

    return {
        "A_x": _A_in["x"],
        "A_k_cache": _A_in["k_cache"],
        "A_v_cache": _A_in["v_cache"],
        "A_wq": _A_in["wq"],
        "A_wo": _A_in["wo"],
        "B_x": _B_in["x"],
        "B_k_cache": _B_in["k_cache"],
        "B_v_cache": _B_in["v_cache"],
        "B_wq": _B_in["wq"],
        "B_wo": _B_in["wo"],
    }

def reference(A_x, A_k_cache, A_v_cache, A_wq, A_wo, B_x, B_k_cache, B_v_cache, B_wq, B_wo):
    def _A_ref(x, k_cache, v_cache, wq, wo):
        B, Sq, D = x.shape
        Hq, Dh = 32, 128
        Hkv, Sk = k_cache.shape[1], k_cache.shape[2]
        W = min(4096, max(256, Sk // 4))
        rep = Hq // Hkv
        q = (lambda x, *d: x.permute(*d))((x @ wq).reshape(B, Sq, Hq, Dh), 0, 2, 1, 3)
        k = (lambda x, n, axis: torch.repeat_interleave(x, n, dim=axis))(k_cache[:, :, Sk - W:, :], rep, axis=1)
        v = (lambda x, n, axis: torch.repeat_interleave(x, n, dim=axis))(v_cache[:, :, Sk - W:, :], rep, axis=1)
        scores = torch.einsum("bhqd,bhkd->bhqk", q, k) * (Dh ** -0.5)
        p = _softmax(scores, axis=-1)
        o = torch.einsum("bhqk,bhkd->bhqd", p, v)
        return (lambda x, *d: x.permute(*d))(o, 0, 2, 1, 3).reshape(B, Sq, Hq * Dh) @ wo

    def _B_ref(x, k_cache, v_cache, wq, wo):
        B, Sq, D = x.shape
        Hq, Dh = 32, 128
        Hkv, Sk = k_cache.shape[1], k_cache.shape[2]
        W = min(4096, max(256, Sk // 4))
        rep = Hq // Hkv
        q = (lambda x, *d: x.permute(*d))((x @ wq).reshape(B, Sq, Hq, Dh), 0, 2, 1, 3)
        k = (lambda x, n, axis: torch.repeat_interleave(x, n, dim=axis))(k_cache[:, :, Sk - W:, :], rep, axis=1)
        v = (lambda x, n, axis: torch.repeat_interleave(x, n, dim=axis))(v_cache[:, :, Sk - W:, :], rep, axis=1)
        scores = torch.einsum("bhqd,bhkd->bhqk", q, k) * (Dh ** -0.5)
        p = _softmax(scores, axis=-1)
        o = torch.einsum("bhqk,bhkd->bhqd", p, v)
        return (lambda x, *d: x.permute(*d))(o, 0, 2, 1, 3).reshape(B, Sq, Hq * Dh) @ wo

    x = A_x
    x = x + _A_ref(_layernorm(x, axis=-1), A_k_cache, A_v_cache, A_wq, A_wo)
    x = x + _B_ref(_layernorm(x, axis=-1), B_k_cache, B_v_cache, B_wq, B_wo)
    x = x + _A_ref(_layernorm(x, axis=-1), A_k_cache, A_v_cache, A_wq, A_wo)
    x = x + _B_ref(_layernorm(x, axis=-1), B_k_cache, B_v_cache, B_wq, B_wo)
    return x
```

```asm
; @launch grid=(256,1,1) block=(640,1,1) lds=159744
.amdgcn_target "amdgcn-amd-amdhsa--gfx950"
.text
.globl interleave_layers__sliding_block_cached__sliding_block_cached__decode_kernel
.p2align 12
.fill 832, 4, 0xbf800000
.p2align 8
.type interleave_layers__sliding_block_cached__sliding_block_cached__decode_kernel,@function
interleave_layers__sliding_block_cached__sliding_block_cached__decode_kernel:
    s_cmp_ge_u32 s2, 256
    s_cbranch_scc1 L_end
    s_load_dwordx16 s[16:31], s[0:1], 0
    s_load_dwordx8 s[32:39], s[0:1], 64
    s_load_dwordx2 s[40:41], s[0:1], 96
    v_lshrrev_b32 v1, 6, v0
    v_and_b32 v0, 63, v0
    v_readfirstlane_b32 s3, v1
    s_and_b32 s4, s2, 7
    s_lshl_b32 s4, s4, 1
    s_lshr_b32 s5, s2, 7
    s_add_u32 s4, s4, s5
    s_lshr_b32 s5, s2, 3
    s_and_b32 s5, s5, 15
    s_cmp_ge_u32 s5, 14
    s_cselect_b32 s57, 32, 16
    s_mov_b32 s43, 400000
    s_and_b32 s12, s5, 7
    s_lshr_b32 s13, s5, 3
    s_cmp_eq_u32 s3, 0
    s_cbranch_scc0 L_compute
    v_lshrrev_b32 v1, 4, v0
    v_and_b32 v2, 15, v0
    v_lshlrev_b32 v3, 1, v1
    v_xor_b32 v3, v3, v2
    v_lshlrev_b32 v3, 4, v3
    v_lshl_add_u32 v10, v1, 13, v3
    v_xor_b32 v11, 0x80, v10
    s_mul_i32 s60, s12, 589824
    s_lshl_b32 s7, s4, 1
    s_add_u32 s7, s7, s13
    s_lshl_b32 s7, s7, 8
    s_add_u32 s60, s60, s7
    s_mov_b32 s46, 4718592
    s_mov_b32 s47, 0x20000
    v_add_u32 v25, 31744, v10
    v_add_u32 v26, 63488, v11
    v_add_u32 v27, 95232, v11
    s_mov_b32 s96, s60
    s_mov_b32 m0, 0
    s_waitcnt lgkmcnt(0)
    s_mov_b64 s[44:45], s[22:23]
    buffer_load_dwordx4 v10, s[44:47], s96 offen offset:0 nt lds
    buffer_load_dwordx4 v25, s[44:47], s96 offen offset:1024 nt lds
    buffer_load_dwordx4 v26, s[44:47], s96 offen offset:2048 nt lds
    buffer_load_dwordx4 v27, s[44:47], s96 offen offset:3072 nt lds
    s_add_u32 m0, m0, 4096
    s_add_u32 s96, s96, 131072
    buffer_load_dwordx4 v10, s[44:47], s96 offen offset:0 nt lds
    buffer_load_dwordx4 v25, s[44:47], s96 offen offset:1024 nt lds
    buffer_load_dwordx4 v26, s[44:47], s96 offen offset:2048 nt lds
    buffer_load_dwordx4 v27, s[44:47], s96 offen offset:3072 nt lds
    s_add_u32 m0, m0, 4096
    s_add_u32 s96, s96, 131072
    buffer_load_dwordx4 v10, s[44:47], s96 offen offset:0 nt lds
    buffer_load_dwordx4 v25, s[44:47], s96 offen offset:1024 nt lds
    buffer_load_dwordx4 v26, s[44:47], s96 offen offset:2048 nt lds
    buffer_load_dwordx4 v27, s[44:47], s96 offen offset:3072 nt lds
    s_add_u32 m0, m0, 4096
    s_add_u32 s96, s96, 131072
    buffer_load_dwordx4 v10, s[44:47], s96 offen offset:0 nt lds
    buffer_load_dwordx4 v25, s[44:47], s96 offen offset:1024 nt lds
    buffer_load_dwordx4 v26, s[44:47], s96 offen offset:2048 nt lds
    buffer_load_dwordx4 v27, s[44:47], s96 offen offset:3072 nt lds
    s_add_u32 m0, m0, 2048
    s_add_u32 s96, s96, 65536
    buffer_load_dwordx4 v26, s[44:47], s96 offen offset:2048 nt lds
    buffer_load_dwordx4 v27, s[44:47], s96 offen offset:3072 nt lds
    s_barrier
    s_branch L_S_lsetup
L_S_cpre:
L_compute:
    s_cmp_eq_u32 s3, 9
    s_cbranch_scc1 L_helper
    s_cmp_eq_u32 s3, 3
    s_cbranch_scc1 L_pad2
    s_cmp_eq_u32 s3, 1
    s_cbranch_scc1 L_pad0
    s_cmp_eq_u32 s3, 2
    s_cbranch_scc1 L_pad1
    s_cmp_eq_u32 s3, 5
    s_cbranch_scc1 L_pad4
    s_cmp_eq_u32 s3, 8
    s_cbranch_scc1 L_pad7
    s_cmp_eq_u32 s3, 4
    s_cbranch_scc1 L_pad3
    s_cmp_eq_u32 s3, 6
    s_cbranch_scc1 L_pad5
    s_cmp_eq_u32 s3, 7
    s_cbranch_scc1 L_pad6
L_padret:
    s_sub_u32 s6, s3, 1
    v_mov_b32 v148, -1
    v_mov_b32 v149, -1
    v_mov_b32 v150, -1
    v_mov_b32 v151, -1
    v_lshlrev_b32 v1, 4, v0
    s_lshl_b32 s7, s6, 10
    s_add_u32 s7, s7, 135168
    v_add_u32 v105, s7, v1
    ds_write_b128 v105, v[148:151] offset:0
    ds_write_b128 v105, v[148:151] offset:8192
    ds_write_b128 v105, v[148:151] offset:16384
    v_and_b32 v106, 15, v0
    v_lshrrev_b32 v107, 4, v0
    v_and_b32 v108, 7, v0
    v_and_b32 v110, 1, v107
    v_lshlrev_b32 v110, 1, v110
    v_lshrrev_b32 v111, 5, v0
    v_add_u32 v110, v110, v111
    s_lshl_b32 s7, s4, 4
    s_add_u32 s59, s7, s5
    s_mul_i32 s60, s4, 60544
    s_add_u32 s60, s60, 4096
    s_and_b32 s98, s6, 3
    s_mul_i32 s99, s12, 9
    s_lshr_b32 s99, s99, 1
    s_add_u32 s99, s99, s6
    v_and_b32 v111, 3, v0
    v_lshl_add_u32 v111, v111, 2, v110
    s_lshl_b32 s7, s99, 4
    v_add_u32 v111, s7, v111
    s_mul_i32 s7, s12, 72
    v_subrev_u32 v112, s7, v111
    v_mov_b32 v113, 72
    v_cmp_lt_u32 s[14:15], v112, v113
    v_bfe_u32 v109, v0, 2, 1
    v_mul_u32_u24 v113, 576, v109
    v_add_lshl_u32 v113, v113, v111, 1
    v_mov_b32 v114, 2147418112
    v_cndmask_b32 v162, v114, v113, s[14:15]
    s_waitcnt lgkmcnt(0)
    s_mov_b64 s[44:45], s[16:17]
    s_mov_b32 s46, 2304
    s_mov_b32 s47, 0x20000
    s_load_dword s18, s[40:41], 0
    buffer_load_ushort v2, v162, s[44:47], 0 offen
    s_barrier
    s_branch L_S_cinit
L_S_hpre:
L_helper:
    v_mov_b32 v8, -1
    v_mov_b32 v36, 0
    v_mov_b32 v9, -1
    v_mov_b32 v37, 0
    v_mov_b32 v10, -1
    v_mov_b32 v38, 0
    v_mov_b32 v11, -1
    v_mov_b32 v39, 0
    v_lshlrev_b32 v1, 4, v0
    s_mul_i32 s47, s4, 60544
    s_add_u32 s47, s47, 4096
    s_mul_i32 s15, s5, 1536
    s_add_u32 s15, s15, s47
    s_add_u32 s15, s15, 25600
    s_lshl_b32 s7, s4, 4
    s_add_u32 s59, s7, s5
    s_mul_i32 s7, s5, 1536
    v_lshl_add_u32 v16, v0, 7, s7
    s_lshl_b32 s7, s12, 7
    s_add_u32 s7, s7, 24576
    v_writelane_b32 v16, s7, 12
    v_lshrrev_b32 v3, 3, v0
    v_and_b32 v4, 7, v0
    v_lshlrev_b32 v4, 4, v4
    v_lshl_add_u32 v3, v3, 11, v4
    s_lshr_b32 s7, s5, 1
    s_mul_i32 s46, s7, 73856
    s_and_b32 s7, s5, 1
    s_mul_i32 s7, s7, 36864
    s_add_u32 s46, s46, s7
    s_lshl_b32 s7, s4, 7
    s_add_u32 s46, s46, s7
    s_add_u32 s46, s46, 1005568
    s_lshl_b32 s7, s5, 2
    v_mov_b32 v20, s7
    v_cmp_gt_u32 vcc, 16, v0
    s_nop 1
    v_cndmask_b32 v20, v20, 0, vcc
    v_add_lshl_u32 v20, v20, v0, 7
    s_mul_i32 s14, s13, 1152
    s_waitcnt lgkmcnt(0)
    s_mov_b64 s[36:37], s[16:17]
    s_mov_b32 s38, 2304
    s_mov_b32 s39, 0x20000
    s_load_dword s18, s[40:41], 0
    s_add_u32 s50, s47, 50176
    s_mov_b64 s[8:9], s[40:41]
    s_mov_b32 s10, 268435456
    s_mov_b32 s11, 0x20000
    s_mov_b64 exec, 0xfffff
    buffer_load_dword v21, v20, s[8:11], s50 offen sc1
    s_mov_b64 exec, -1
    s_lshl_b32 s7, s5, 2
    s_add_u32 s52, s50, s7
    v_lshlrev_b32 v20, 7, v0
    s_mov_b64 exec, 0x1fff
    buffer_load_dword v17, v16, s[8:11], s47 offen sc1
    s_mov_b64 exec, -1
    buffer_store_dwordx4 v[8:11], v1, s[8:11], s15 offen sc1
    buffer_load_dwordx4 v[28:31], v1, s[36:39], s14 offen
    s_mov_b32 exec_hi, 0
    buffer_store_dwordx4 v[8:11], v1, s[8:11], s15 offen offset:1024 sc1
    s_mov_b64 exec, 0xff
    buffer_load_dwordx4 v[36:39], v1, s[36:39], s14 offen offset:1024
    s_mov_b64 exec, -1
L_S_hpost:
    s_getreg_b32 s19, hwreg(HW_REG_XCC_ID, 0, 4)
    v_lshlrev_b32 v6, 7, v0
    s_waitcnt lgkmcnt(0)
    s_and_b32 s18, s18, 0x7f7f7f7f
    s_add_u32 s18, s18, 0x07050301
    s_and_b32 s18, s18, 0x7f7f7f7f
    s_mov_b32 s54, s18
    s_xor_b32 s18, s18, s19
    s_mov_b32 s19, s18
    v_mov_b32 v12, s18
    v_mov_b32 v13, s18
    v_mov_b32 v14, s18
    v_mov_b32 v15, s18
    s_lshl_b32 s45, s59, 7
    s_add_u32 s45, s45, 972800
    s_mov_b64 exec, 0xffff
    buffer_store_dword v12, v20, s[8:11], s52 offen
    s_mov_b64 exec, -1
    s_barrier
    s_mov_b32 s53, 15
    v_mov_b32 v18, 158336
    v_mov_b32 v19, 1
L_xf:
    s_load_dwordx16 s[20:35], s[40:41], s50
    s_add_u32 s50, s50, 128
    s_waitcnt lgkmcnt(0)
    s_xor_b64 s[20:21], s[20:21], s[18:19]
    s_xor_b64 s[22:23], s[22:23], s[18:19]
    s_xor_b64 s[24:25], s[24:25], s[18:19]
    s_xor_b64 s[26:27], s[26:27], s[18:19]
    s_xor_b64 s[28:29], s[28:29], s[18:19]
    s_xor_b64 s[30:31], s[30:31], s[18:19]
    s_xor_b64 s[32:33], s[32:33], s[18:19]
    s_xor_b64 s[34:35], s[34:35], s[18:19]
    s_or_b64 s[20:21], s[20:21], s[22:23]
    s_or_b64 s[20:21], s[20:21], s[24:25]
    s_or_b64 s[20:21], s[20:21], s[26:27]
    s_or_b64 s[20:21], s[20:21], s[28:29]
    s_or_b64 s[20:21], s[20:21], s[30:31]
    s_or_b64 s[20:21], s[20:21], s[32:33]
    s_or_b64 s[20:21], s[20:21], s[34:35]
    s_cbranch_scc1 L_xf2
    ds_write_b32 v18, v19 offset:8
L_xfd:
    s_waitcnt vmcnt(0)
    s_mov_b64 exec, 0xff
    buffer_store_dwordx4 v[12:15], v1, s[8:11], s45 offen sc1
    s_mov_b64 exec, 0xfff
    buffer_load_dword v5, v6, s[8:11], s15 offen sc1
    s_mov_b64 exec, -1
    s_add_u32 s7, s46, 590848
    buffer_store_dwordx4 v[8:11], v3, s[8:11], s7 offen sc1
    s_add_u32 s7, s46, 607232
    buffer_store_dwordx4 v[8:11], v3, s[8:11], s7 offen sc1
    s_add_u32 s7, s46, 623616
    s_mov_b64 exec, 0xffff
    buffer_store_dwordx4 v[8:11], v3, s[8:11], s7 offen sc1
    s_mov_b64 exec, -1
    s_add_u32 s7, s46, 1181696
    buffer_store_dwordx4 v[8:11], v3, s[8:11], s7 offen sc1
    s_add_u32 s7, s46, 1198080
    buffer_store_dwordx4 v[8:11], v3, s[8:11], s7 offen sc1
    s_add_u32 s7, s46, 1214464
    s_mov_b64 exec, 0xffff
    buffer_store_dwordx4 v[8:11], v3, s[8:11], s7 offen sc1
    s_mov_b64 exec, -1
    s_cmp_lt_u32 s5, 4
    s_cbranch_scc0 L_ap3
    s_add_u32 s7, s46, 1772544
    buffer_store_dwordx4 v[8:11], v3, s[8:11], s7 offen sc1
    s_add_u32 s7, s46, 1788928
    buffer_store_dwordx4 v[8:11], v3, s[8:11], s7 offen sc1
    s_add_u32 s7, s46, 1805312
    s_mov_b64 exec, 0xffff
    buffer_store_dwordx4 v[8:11], v3, s[8:11], s7 offen sc1
    s_mov_b64 exec, -1
L_ap3:
    s_mov_b32 s55, 0x3f803f80
    v_mov_b32 v19, 0x3727c5ac
    s_mov_b32 s100, 0x3ae38e39
    s_mov_b32 s101, 0x3e0293ee
    v_dot2_f32_bf16 v32, v28, v28, 0
    v_dot2_f32_bf16 v33, v28, s55, 0
    v_dot2_f32_bf16 v32, v29, v29, v32
    v_dot2_f32_bf16 v33, v29, s55, v33
    v_dot2_f32_bf16 v32, v30, v30, v32
    v_dot2_f32_bf16 v33, v30, s55, v33
    v_dot2_f32_bf16 v32, v31, v31, v32
    v_dot2_f32_bf16 v33, v31, s55, v33
    v_dot2_f32_bf16 v32, v36, v36, v32
    v_dot2_f32_bf16 v33, v36, s55, v33
    v_dot2_f32_bf16 v32, v37, v37, v32
    v_dot2_f32_bf16 v33, v37, s55, v33
    v_dot2_f32_bf16 v32, v38, v38, v32
    v_dot2_f32_bf16 v33, v38, s55, v33
    v_dot2_f32_bf16 v32, v39, v39, v32
    v_dot2_f32_bf16 v33, v39, s55, v33
    v_and_b32 v2, 15, v0
    s_mul_i32 s7, s13, 320
    s_add_u32 s7, s7, 135168
    v_lshl_add_u32 v24, v2, 4, s7
    s_mov_b32 s7, 138464
    v_lshl_add_u32 v25, v2, 2, s7
    s_mov_b32 s7, 138592
    v_lshl_add_u32 v26, v2, 3, s7
    s_mov_b32 s7, 138720
    v_lshrrev_b32 v7, 1, v2
    v_lshl_add_u32 v7, v7, 2, s7
    v_and_b32 v2, 32, v0
    v_add_u32 v7, v7, v2
    v_and_b32 v2, 16, v0
    v_lshl_add_u32 v27, v2, 2, v7
    s_lshl_b32 s7, s13, 8
    s_add_u32 s7, s7, 24576
    v_add_u32 v22, s7, v4
    s_add_u32 s56, s7, s47
    s_lshl_b32 s7, s12, 4
    s_add_u32 s56, s56, s7
    s_add_u32 s51, s47, 41984
    v_add_f32_dpp v32, v32, v32 quad_perm:[1,0,3,2] row_mask:0xf bank_mask:0xf
    v_add_f32_dpp v33, v33, v33 quad_perm:[1,0,3,2] row_mask:0xf bank_mask:0xf
    s_nop 0
    v_add_f32_dpp v32, v32, v32 quad_perm:[2,3,0,1] row_mask:0xf bank_mask:0xf
    v_add_f32_dpp v33, v33, v33 quad_perm:[2,3,0,1] row_mask:0xf bank_mask:0xf
    s_nop 0
    v_add_f32_dpp v32, v32, v32 row_half_mirror row_mask:0xf bank_mask:0xf
    v_add_f32_dpp v33, v33, v33 row_half_mirror row_mask:0xf bank_mask:0xf
    s_nop 0
    v_add_f32_dpp v32, v32, v32 row_ror:8 row_mask:0xf bank_mask:0xf
    v_add_f32_dpp v33, v33, v33 row_ror:8 row_mask:0xf bank_mask:0xf
    v_mov_b64 v[34:35], v[32:33]
    s_nop 1
    v_permlane16_swap_b32 v32, v34
    v_permlane16_swap_b32 v33, v35
    v_pk_add_f32 v[32:33], v[32:33], v[34:35]
    v_mov_b64 v[34:35], v[32:33]
    s_nop 1
    v_permlane32_swap_b32 v32, v34
    v_permlane32_swap_b32 v33, v35
    v_pk_add_f32 v[32:33], v[32:33], v[34:35]
    v_mul_f32 v33, s100, v33
    v_fma_f32 v32, v32, s100, v19
    v_fma_f32 v32, -v33, v33, v32
    v_max_f32 v32, v19, v32
    v_rsq_f32 v32, v32
    v_mul_f32 v33, s101, v33
    v_mul_f32 v33, -v33, v32
    v_mul_f32 v32, s101, v32
    ds_write_b64 v26, v[32:33]
    s_lshl_b32 s7, s4, 11
    s_add_u32 s7, s7, 972800
    s_add_u32 s48, s40, s7
    s_addc_u32 s49, s41, 0
    s_waitcnt vmcnt(0)
L_gc0:
    s_load_dword s20, s[48:49], 0 glc
    s_load_dword s21, s[48:49], 128 glc
    s_load_dword s22, s[48:49], 256 glc
    s_load_dword s23, s[48:49], 384 glc
    s_load_dword s24, s[48:49], 512 glc
    s_load_dword s25, s[48:49], 640 glc
    s_load_dword s26, s[48:49], 768 glc
    s_load_dword s27, s[48:49], 896 glc
    s_load_dword s28, s[48:49], 1024 glc
    s_load_dword s29, s[48:49], 1152 glc
    s_load_dword s30, s[48:49], 1280 glc
    s_load_dword s31, s[48:49], 1408 glc
    s_load_dword s32, s[48:49], 1536 glc
    s_load_dword s33, s[48:49], 1664 glc
    s_load_dword s34, s[48:49], 1792 glc
    s_load_dword s35, s[48:49], 1920 glc
    s_waitcnt lgkmcnt(0)
    s_xor_b64 s[20:21], s[20:21], s[18:19]
    s_xor_b64 s[22:23], s[22:23], s[18:19]
    s_xor_b64 s[24:25], s[24:25], s[18:19]
    s_xor_b64 s[26:27], s[26:27], s[18:19]
    s_xor_b64 s[28:29], s[28:29], s[18:19]
    s_xor_b64 s[30:31], s[30:31], s[18:19]
    s_xor_b64 s[32:33], s[32:33], s[18:19]
    s_xor_b64 s[34:35], s[34:35], s[18:19]
    s_or_b64 s[20:21], s[20:21], s[22:23]
    s_or_b64 s[20:21], s[20:21], s[24:25]
    s_or_b64 s[20:21], s[20:21], s[26:27]
    s_or_b64 s[20:21], s[20:21], s[28:29]
    s_or_b64 s[20:21], s[20:21], s[30:31]
    s_or_b64 s[20:21], s[20:21], s[32:33]
    s_or_b64 s[20:21], s[20:21], s[34:35]
    s_or_b32 s20, s20, s21
    s_cmp_gt_u32 s20, 15
    s_cbranch_scc1 L_rt_28
    s_cmp_eq_u32 s20, 0
    s_cselect_b32 s58, 1, 0
    v_mov_b32 v2, s58
    ds_write_b32 v18, v2
    ds_write_b32 v18, v2 offset:8
    s_mov_b32 s18, s54
    s_mov_b32 s42, 0
    s_mov_b64 s[20:21], 0
    s_mov_b64 s[22:23], 0
    s_mov_b64 exec, 0
    s_branch L_S_hloop
L_pad0:
    s_branch L_padret
L_S_cinit:
    s_mov_b64 s[8:9], s[40:41]
    s_mov_b32 s10, 268435456
    s_mov_b32 s11, 0x20000
    v_lshrrev_b32 v120, 3, v106
    v_mul_u32_u24 v120, 544, v120
    v_lshl_add_u32 v120, v108, 6, v120
    v_lshl_add_u32 v120, v107, 4, v120
    v_add_u32 v157, 137280, v120
    s_mul_i32 s7, s98, 5760
    v_mov_b32 v116, 0
    v_mov_b32 v117, 0
    s_cmp_lt_u32 s6, 4
    s_cbranch_scc1 L_const_x
    v_and_b32 v120, 1, v0
    v_lshlrev_b32 v120, 3, v120
    v_sub_u32 v120, v157, v120
    v_add_u32 v120, s7, v120
    ds_write_b64 v120, v[116:117] offset:8
    s_branch L_const_done
L_const_x:
    s_add_u32 s7, s7, 135168
    v_add_u32 v115, s7, v1
    s_mov_b32 exec_lo, 0
    s_mov_b32 exec_hi, 0x1ff00
    v_mov_b32 v116, 0x3f803f80
    s_mov_b32 exec_lo, 0xe00ffe00
    s_mov_b32 exec_hi, 0xfffff
    v_mov_b32 v117, v116
    v_mov_b32 v118, v116
    v_mov_b32 v119, v116
    ds_write_b128 v115, v[116:119]
    s_mov_b64 exec, -1
L_const_done:
    s_lshr_b32 s7, s4, 1
    s_mul_i32 s7, s7, 73856
    s_lshl_b32 s23, s99, 11
    s_add_u32 s23, s23, s7
    s_add_u32 s23, s23, 1005568
    s_add_u32 s24, s23, 590848
    s_and_b32 s7, s6, 6
    s_mul_i32 s7, s7, 73856
    s_add_u32 s25, s7, 1005568
    s_add_u32 s26, s7, 1596416
    v_lshrrev_b32 v124, 2, v106
    v_and_b32 v125, 3, v106
    v_and_b32 v126, 1, v107
    v_lshrrev_b32 v127, 1, v107
    v_bfe_u32 v128, v0, 1, 1
    v_and_b32 v120, 0x31, v112
    v_and_b32 v121, 12, v112
    v_lshl_add_u32 v120, v120, 1, v121
    v_and_b32 v121, 2, v112
    v_lshl_add_u32 v120, v121, 3, v120
    v_lshlrev_b32 v121, 1, v112
    v_cmp_gt_u32 vcc, 64, v112
    s_nop 1
    v_cndmask_b32 v120, v121, v120, vcc
    v_mul_u32_u24 v122, 320, v109
    v_add_u32 v120, v120, v122
    v_add_u32 v120, 135168, v120
    v_mov_b32 v121, 137792
    v_cndmask_b32 v3, v121, v120, s[14:15]
    v_lshlrev_b32 v123, 5, v107
    v_lshl_add_u32 v123, v128, 4, v123
    v_and_b32 v120, 1, v0
    v_mul_u32_u24 v120, 640, v120
    v_add3_u32 v120, v120, v122, v123
    v_add_u32 v154, 136000, v120
    v_min_u32 v120, 2, v124
    v_mul_u32_u24 v120, 320, v120
    v_add_u32 v120, 135168, v120
    v_add_u32 v4, v120, v123
    v_mov_b32 v152, 135312
    s_mov_b32 exec_lo, 0
    s_mov_b32 exec_hi, 0x33330000
    v_add_u32 v152, 128, v120
    s_mov_b64 exec, -1
    v_lshl_add_u32 v120, v107, 3, v124
    v_lshlrev_b32 v120, 8, v120
    v_lshl_or_b32 v121, v126, 2, v124
    v_xor_b32 v121, s6, v121
    v_lshl_add_u32 v120, v121, 5, v120
    v_lshl_add_u32 v5, v125, 3, v120
    s_lshl_b32 s7, s13, 12
    s_lshr_b32 s14, s6, 1
    s_lshl_b32 s14, s14, 10
    s_add_u32 s7, s7, s14
    s_lshl_b32 s14, s12, 7
    s_add_u32 s7, s7, s14
    s_and_b32 s15, s6, 1
    s_lshl_b32 s14, s15, 6
    s_add_u32 s7, s7, s14
    v_lshl_add_u32 v120, v106, 2, s7
    v_lshl_add_u32 v120, v107, 13, v120
    v_cmp_gt_u32 vcc, 3, v107
    s_nop 1
    v_cndmask_b32 v6, v114, v120, vcc
    s_lshl_b32 s7, s6, 10
    s_add_u32 s63, s60, s7
    s_lshl_b32 s7, s13, 13
    s_add_u32 s62, s63, s7
    s_add_u32 s63, s63, 16384
    s_lshr_b32 s100, s6, 2
    s_mul_i32 s7, s100, 320
    s_lshl_b32 s101, s98, 6
    s_add_u32 s7, s7, s101
    s_add_u32 s7, s7, 136000
    v_lshl_add_u32 v120, v109, 5, s7
    v_lshl_add_u32 v120, v126, 4, v120
    v_lshl_add_u32 v120, v125, 2, v120
    v_lshl_add_u32 v153, v127, 1, v120
    s_lshl_b32 s15, s15, 3
    s_lshl_b32 s14, s100, 1
    s_add_u32 s14, s14, s15
    s_lshl_b32 s7, s6, 6
    s_add_u32 s7, s7, s15
    s_add_u32 s7, s7, 137280
    v_xor_b32 v120, s14, v106
    v_and_b32 v121, 3, v120
    v_lshrrev_b32 v120, 2, v120
    v_lshl_add_u32 v121, v121, 1, s7
    v_lshl_add_u32 v120, v120, 4, v121
    v_mul_u32_u24 v121, 544, v126
    v_add_u32 v155, v120, v121
    s_lshl_b32 s7, s6, 2
    s_add_u32 s7, s7, 138464
    v_lshl_add_u32 v156, v126, 5, s7
    s_lshl_b32 s27, s13, 9
    s_lshl_b32 s7, s12, 5
    s_add_u32 s27, s27, s7
    s_lshl_b32 s7, s100, 4
    s_add_u32 s27, s27, s7
    s_and_b32 s7, s6, 2
    s_lshl_b32 s7, s7, 9
    s_add_u32 s27, s27, s7
    s_add_u32 s27, s27, s15
    s_add_u32 s27, s27, s60
    s_add_u32 s27, s27, 41984
    s_lshl_b32 s7, s100, 6
    s_add_u32 s7, s7, 138592
    v_lshl_add_u32 v160, v107, 4, s7
    v_lshl_add_u32 v120, v126, 2, v106
    v_and_b32 v120, 7, v120
    v_lshl_add_u32 v120, v127, 3, v120
    v_lshlrev_b32 v121, 2, v120
    v_add_u32 v158, 138464, v121
    v_cmp_eq_u32 s[14:15], 0, v126
    s_lshl_b32 s7, s6, 9
    s_lshl_b32 s101, s5, 4
    s_add_u32 s7, s7, s101
    s_add_u32 s7, s7, 25600
    v_lshlrev_b32 v120, 12, v127
    v_lshrrev_b32 v121, 3, v106
    v_lshl_add_u32 v120, v121, 8, v120
    v_lshl_add_u32 v120, v108, 1, v120
    v_add_u32 v120, s7, v120
    v_cndmask_b32 v159, v114, v120, s[14:15]
    s_branch L_S_cinit2
L_pad1:
    s_branch L_padret
L_S_cinit2:
    s_lshr_b32 s15, s57, 5
    s_lshl_b32 s7, s5, 1
    s_cmp_eq_u32 s5, 15
    s_cselect_b32 s7, 32, s7
    s_and_b32 s14, s6, 1
    s_lshl_b32 s14, s14, s15
    s_add_u32 s7, s7, s14
    s_lshl_b32 s7, s7, 4
    s_add_u32 s7, s7, s4
    s_lshl_b32 s7, s7, 7
    s_movk_i32 s14, 2048
    s_cmp_eq_u32 s15, 0
    s_cselect_b32 s14, 73856, s14
    v_and_b32 v120, 31, v0
    v_lshl_add_u32 v120, v120, 2, s7
    v_mad_u32_u24 v161, s14, v127, v120
    s_mov_b32 s42, 0
    s_add_u32 s20, s60, 8192
    s_andn2_b32 s7, s6, s15
    s_lshl_b32 s7, s7, 10
    s_add_u32 s7, s7, s60
    s_add_u32 s21, s7, 25600
    s_add_u32 s22, s7, 33792
    s_and_b32 s14, s6, 1
    s_lshl_b32 s14, s14, 10
    s_add_u32 s28, s14, 138880
    s_lshr_b32 s7, s6, s15
    v_lshrrev_b32 v120, 3, v0
    v_add_u32 v120, s7, v120
    v_and_b32 v120, 3, v120
    v_lshlrev_b32 v120, 2, v120
    v_lshl_add_u32 v120, v106, 4, v120
    v_lshl_add_u32 v120, v127, 8, v120
    s_sub_u32 s7, 10, s15
    v_lshl_add_u32 v120, v126, s7, v120
    s_lshl_b32 s7, s100, 9
    s_cmp_eq_u32 s15, 0
    s_cselect_b32 s7, s7, s14
    s_add_u32 s7, s7, 138880
    v_add_u32 v163, s7, v120
    v_mov_b32 v121, 0xaaaa
    v_mul_u32_u24 v122, v121, v128
    v_mul_u32_u24 v121, v121, v109
    v_lshl_or_b32 v121, v121, 16, v122
    v_or_b32 v165, 0x44444444, v121
    v_mov_b32 v121, 12
    v_cmp_eq_u32 vcc, 0, v125
    s_nop 1
    v_cndmask_b32 v121, v121, v124, vcc
    v_lshl_or_b32 v164, v121, 16, v125
    s_waitcnt lgkmcnt(0)
    s_and_b32 s18, s18, 0x7f7f7f7f
    s_add_u32 s18, s18, 0x07050301
    s_and_b32 s18, s18, 0x7f7f7f7f
    v_perm_b32 v7, s18, s18, v164
    s_waitcnt vmcnt(0)
    s_cmp_lt_u32 s6, 5
    s_cbranch_scc0 L_nox0
    ds_write_b16 v3, v2
L_nox0:
    v_lshlrev_b32 v2, 16, v2
    s_add_u32 s61, s60, 52224
    s_lshr_b32 s56, s57, 5
    s_mul_i32 s96, s56, s57
    s_mov_b32 s14, 18
    v_mov_b32 v148, 158208
L_f0w:
    ds_read_b32 v149, v148
    ds_read_b32 v150, v148 offset:136
    s_waitcnt lgkmcnt(0)
    v_add_u32 v151, 18, v150
    v_min_i32 v149, v149, v151
    v_readfirstlane_b32 s58, v150
    v_cmp_gt_i32 vcc, s14, v149
    s_cbranch_vccnz L_rt_36
    ds_read_b64_tr_b16 v[112:113], v5 offset:10240
    ds_read_b64_tr_b16 v[114:115], v5 offset:11264
    ds_read_b64_tr_b16 v[104:105], v5 offset:0
    ds_read_b64_tr_b16 v[106:107], v5 offset:1024
    ds_read_b64_tr_b16 v[108:109], v5 offset:8192
    ds_read_b64_tr_b16 v[110:111], v5 offset:9216
    s_branch L_P2_0
L_xf2:
    s_sleep 2
    s_sub_u32 s53, s53, 1
    s_cbranch_scc0 L_xf
    s_branch L_xfd
L_rt_28:
    s_sleep 4
    s_sub_u32 s43, s43, 1
    s_cbranch_scc0 L_gc0
    s_endpgm
L_rt_36:
    s_sleep 1
    s_sub_u32 s43, s43, 1
    s_cbranch_scc0 L_f0w
    s_endpgm
L_rt_5:
    s_sleep 1
    s_sub_u32 s43, s43, 1
    s_cbranch_scc0 L_wc_4
    s_endpgm
L_rt_8:
    s_sleep 1
    s_sub_u32 s43, s43, 1
    s_cbranch_scc0 L_wc_7
    s_endpgm
L_rt_12:
    s_sleep 1
    s_sub_u32 s43, s43, 1
    s_cbranch_scc0 L_wc_11
    s_endpgm
L_rt_19:
    s_sleep 1
    s_sub_u32 s43, s43, 1
    s_cbranch_scc0 L_wc_18
    s_endpgm
L_rt_22:
    s_sleep 1
    s_sub_u32 s43, s43, 1
    s_cbranch_scc0 L_wc_21
    s_endpgm
L_rt_26:
    s_sleep 1
    s_sub_u32 s43, s43, 1
    s_cbranch_scc0 L_wc_25
    s_endpgm
L_ePG1:
    .p2align 12
L_PG1:
L_pad2:
    s_branch L_padret
L_S_lsetup:
    v_mov_b32 v24, 0
    v_mov_b32 v20, 158208
    v_lshl_add_u32 v12, v1, 8, v3
    v_xor_b32 v13, 0x80, v12
    v_xor_b32 v3, v1, v2
    v_lshlrev_b32 v3, 4, v3
    v_lshl_add_u32 v14, v1, 8, v3
    v_xor_b32 v15, 0x40, v14
    v_xor_b32 v16, 0x80, v14
    v_xor_b32 v17, 0xc0, v14
    s_lshl_b32 s61, s13, 24
    s_lshl_b32 s7, s4, 20
    s_add_u32 s61, s61, s7
    s_lshl_b32 s7, s12, 11
    s_add_u32 s61, s61, s7
    s_add_u32 s61, s61, 786432
    s_mul_i32 s62, s4, 294912
    s_lshl_b32 s7, s5, 6
    s_cmp_eq_u32 s5, 15
    s_cselect_b32 s7, 1024, s7
    s_add_u32 s62, s62, s7
    v_lshrrev_b32 v4, 2, v0
    v_and_b32 v5, 3, v0
    v_lshrrev_b32 v6, 5, v0
    v_lshlrev_b32 v6, 1, v6
    v_xor_b32 v5, v5, v6
    v_lshlrev_b32 v5, 4, v5
    v_mul_u32_u24 v4, 1152, v4
    v_add_u32 v18, v4, v5
    v_mov_b32 v19, v18
    s_mov_b32 s63, 18432
    s_cmp_ge_u32 s5, 14
    s_cbranch_scc0 L_ld_wo_done
    v_lshrrev_b32 v4, 3, v0
    v_and_b32 v5, 7, v0
    v_and_b32 v6, 1, v1
    v_lshlrev_b32 v6, 1, v6
    v_xor_b32 v5, v5, v6
    v_lshlrev_b32 v5, 4, v5
    v_mul_u32_u24 v4, 1152, v4
    v_add_u32 v18, v4, v5
    v_xor_b32 v5, 0x40, v5
    v_add_u32 v19, v4, v5
    s_mov_b32 s63, 9216
L_ld_wo_done:
    s_mov_b32 s50, 33554432
    s_mov_b32 s51, 0x20000
    s_mov_b32 s54, 33554432
    s_mov_b32 s55, 0x20000
    s_mov_b32 s58, 4718592
    s_mov_b32 s59, 0x20000
    s_lshr_b32 s15, s57, 2
    v_and_b32 v22, 7, v0
    v_lshlrev_b32 v22, 2, v22
    v_add_u32 v22, 158272, v22
    v_add_u32 v13, 14336, v13
    v_add_u32 v16, 14336, v16
    v_add_u32 v17, 14336, v17
    s_sub_u32 s7, s63, 1024
    v_add_u32 v19, s7, v19
    s_lshl_b32 s7, s7, 1
    v_add_u32 v28, s7, v18
    v_add_u32 v29, s7, v19
    s_lshl_b32 s63, s63, 2
    s_mov_b64 s[48:49], s[18:19]
    s_mov_b64 s[52:53], s[20:21]
    s_mov_b64 s[56:57], s[24:25]
    s_cmp_ge_u32 s5, 14
    s_cbranch_scc1 L_ldO
L_S_ld:
    v_mov_b32 v21, 1
    s_mov_b32 s96, s61
    s_mov_b32 m0, 36864
    s_mov_b32 s97, 8
L_seg_1:
    s_waitcnt vmcnt(17)
    buffer_load_dwordx4 v14, s[48:51], s96 offen offset:0 nt lds
    v_max_i32 v24, v24, v21
    buffer_load_dwordx4 v15, s[48:51], s96 offen offset:1024 nt lds
    ds_write_b32 v20, v24
    v_add_u32 v21, 4, v21
    buffer_load_dwordx4 v16, s[48:51], s96 offen offset:2048 nt lds
    buffer_load_dwordx4 v17, s[48:51], s96 offen offset:3072 nt lds
    s_add_u32 m0, m0, 4096
    s_add_u32 s96, s96, 32768
    s_sub_u32 s97, s97, 1
    s_cmp_lg_u32 s97, 0
    s_cbranch_scc1 L_seg_1
    s_mov_b32 s96, s61
    s_mov_b32 m0, 69632
    s_mov_b32 s97, 8
L_seg_2:
    s_waitcnt vmcnt(17)
    buffer_load_dwordx4 v12, s[52:55], s96 offen offset:0 nt lds
    v_max_i32 v24, v24, v21
    buffer_load_dwordx4 v12, s[52:55], s96 offen offset:1024 nt lds
    ds_write_b32 v20, v24
    v_add_u32 v21, 4, v21
    buffer_load_dwordx4 v13, s[52:55], s96 offen offset:2048 nt lds
    buffer_load_dwordx4 v13, s[52:55], s96 offen offset:3072 nt lds
    s_add_u32 m0, m0, 4096
    s_add_u32 s96, s96, 32768
    s_sub_u32 s97, s97, 1
    s_cmp_lg_u32 s97, 0
    s_cbranch_scc1 L_seg_2
    s_mov_b32 s96, s62
    s_mov_b32 m0, 102400
    s_mov_b32 s97, s15
L_seg_3:
    s_waitcnt vmcnt(17)
    buffer_load_dwordx4 v18, s[56:59], s96 offen offset:0 nt lds
    v_max_i32 v24, v24, v21
    buffer_load_dwordx4 v19, s[56:59], s96 offen offset:1024 nt lds
    ds_write_b32 v20, v24
    v_add_u32 v21, 4, v21
    buffer_load_dwordx4 v28, s[56:59], s96 offen offset:2048 nt lds
    buffer_load_dwordx4 v29, s[56:59], s96 offen offset:3072 nt lds
    s_add_u32 m0, m0, 4096
    s_add_u32 s96, s96, s63
    s_sub_u32 s97, s97, 1
    s_cmp_lg_u32 s97, 0
    s_cbranch_scc1 L_seg_3
    s_mov_b64 s[44:45], s[32:33]
    s_mov_b32 s96, s60
    s_mov_b32 m0, 18432
    s_waitcnt vmcnt(17)
    buffer_load_dwordx4 v10, s[44:47], s96 offen offset:0 nt lds
    v_max_i32 v24, v24, v21
    buffer_load_dwordx4 v25, s[44:47], s96 offen offset:1024 nt lds
    ds_write_b32 v20, v24
    v_add_u32 v21, 4, v21
    buffer_load_dwordx4 v26, s[44:47], s96 offen offset:2048 nt lds
    buffer_load_dwordx4 v27, s[44:47], s96 offen offset:3072 nt lds
    s_add_u32 m0, m0, 4096
    s_add_u32 s96, s96, 131072
    s_waitcnt vmcnt(17)
    buffer_load_dwordx4 v10, s[44:47], s96 offen offset:0 nt lds
    v_max_i32 v24, v24, v21
    buffer_load_dwordx4 v25, s[44:47], s96 offen offset:1024 nt lds
    ds_write_b32 v20, v24
    v_add_u32 v21, 4, v21
    buffer_load_dwordx4 v26, s[44:47], s96 offen offset:2048 nt lds
    buffer_load_dwordx4 v27, s[44:47], s96 offen offset:3072 nt lds
    s_add_u32 m0, m0, 4096
    s_add_u32 s96, s96, 131072
    s_waitcnt vmcnt(17)
    buffer_load_dwordx4 v10, s[44:47], s96 offen offset:0 nt lds
    v_max_i32 v24, v24, v21
    buffer_load_dwordx4 v25, s[44:47], s96 offen offset:1024 nt lds
    ds_write_b32 v20, v24
    v_add_u32 v21, 4, v21
    buffer_load_dwordx4 v26, s[44:47], s96 offen offset:2048 nt lds
    buffer_load_dwordx4 v27, s[44:47], s96 offen offset:3072 nt lds
    s_add_u32 m0, m0, 4096
    s_add_u32 s96, s96, 131072
    s_waitcnt vmcnt(17)
    buffer_load_dwordx4 v10, s[44:47], s96 offen offset:0 nt lds
    v_max_i32 v24, v24, v21
    buffer_load_dwordx4 v25, s[44:47], s96 offen offset:1024 nt lds
    ds_write_b32 v20, v24
    v_add_u32 v21, 4, v21
    buffer_load_dwordx4 v26, s[44:47], s96 offen offset:2048 nt lds
    buffer_load_dwordx4 v27, s[44:47], s96 offen offset:3072 nt lds
    s_add_u32 m0, m0, 2048
    s_add_u32 s96, s96, 65536
    s_waitcnt vmcnt(17)
    buffer_load_dwordx4 v26, s[44:47], s96 offen offset:2048 nt lds
    v_max_i32 v24, v24, v21
    buffer_load_dwordx4 v27, s[44:47], s96 offen offset:3072 nt lds
    ds_write_b32 v20, v24
    v_add_u32 v21, 2, v21
L_wc_4:
    ds_read_b32 v23, v22
    s_waitcnt lgkmcnt(0)
    v_cmp_gt_i32 vcc, 1, v23
    s_cbranch_vccnz L_rt_5
    s_mov_b64 s[48:49], s[28:29]
    s_mov_b32 s96, s61
    s_mov_b32 m0, 36864
    s_mov_b32 s97, 8
L_seg_6:
    s_waitcnt vmcnt(17)
    buffer_load_dwordx4 v14, s[48:51], s96 offen offset:0 nt lds
    v_max_i32 v24, v24, v21
    buffer_load_dwordx4 v15, s[48:51], s96 offen offset:1024 nt lds
    ds_write_b32 v20, v24
    v_add_u32 v21, 4, v21
    buffer_load_dwordx4 v16, s[48:51], s96 offen offset:2048 nt lds
    buffer_load_dwordx4 v17, s[48:51], s96 offen offset:3072 nt lds
    s_add_u32 m0, m0, 4096
    s_add_u32 s96, s96, 32768
    s_sub_u32 s97, s97, 1
    s_cmp_lg_u32 s97, 0
    s_cbranch_scc1 L_seg_6
L_wc_7:
    ds_read_b32 v23, v22
    s_waitcnt lgkmcnt(0)
    v_cmp_gt_i32 vcc, 2, v23
    s_cbranch_vccnz L_rt_8
    ds_read_b32 v23, v22
    s_waitcnt lgkmcnt(0)
    v_cmp_gt_i32 vcc, 3, v23
    v_add_u32 v21, 21, v21
    s_cmp_eq_u64 vcc, 0
    s_cselect_b32 s13, 37, 18
    v_subrev_u32 v21, s13, v21
    s_mov_b64 s[52:53], s[30:31]
    s_mov_b32 s96, s61
    s_mov_b32 m0, 69632
    s_mov_b32 s97, 8
L_seg_9:
    s_waitcnt vmcnt(33)
    s_cmp_eq_u32 s13, 37
    s_cbranch_scc1 L_ad_10
    s_waitcnt vmcnt(14)
L_ad_10:
    buffer_load_dwordx4 v12, s[52:55], s96 offen offset:0 nt lds
    v_max_i32 v24, v24, v21
    buffer_load_dwordx4 v12, s[52:55], s96 offen offset:1024 nt lds
    ds_write_b32 v20, v24
    v_add_u32 v21, 4, v21
    buffer_load_dwordx4 v13, s[52:55], s96 offen offset:2048 nt lds
    buffer_load_dwordx4 v13, s[52:55], s96 offen offset:3072 nt lds
    s_add_u32 m0, m0, 4096
    s_add_u32 s96, s96, 32768
    s_sub_u32 s97, s97, 1
    s_cmp_lg_u32 s97, 0
    s_cbranch_scc1 L_seg_9
L_wc_11:
    ds_read_b32 v23, v22
    s_waitcnt lgkmcnt(0)
    v_cmp_gt_i32 vcc, 4, v23
    s_cbranch_vccnz L_rt_12
    ds_read_b32 v23, v22
    s_waitcnt lgkmcnt(0)
    v_cmp_gt_i32 vcc, 5, v23
    v_add_u32 v21, s13, v21
    s_cmp_eq_u64 vcc, 0
    s_cselect_b32 s13, 37, 18
    v_subrev_u32 v21, s13, v21
    s_mov_b64 s[56:57], s[34:35]
    s_mov_b32 s96, s62
    s_mov_b32 m0, 102400
    s_mov_b32 s97, s15
L_seg_13:
    s_waitcnt vmcnt(33)
    s_cmp_eq_u32 s13, 37
    s_cbranch_scc1 L_ad_14
    s_waitcnt vmcnt(14)
L_ad_14:
    buffer_load_dwordx4 v18, s[56:59], s96 offen offset:0 nt lds
    v_max_i32 v24, v24, v21
    buffer_load_dwordx4 v19, s[56:59], s96 offen offset:1024 nt lds
    ds_write_b32 v20, v24
    v_add_u32 v21, 4, v21
    buffer_load_dwordx4 v28, s[56:59], s96 offen offset:2048 nt lds
    buffer_load_dwordx4 v29, s[56:59], s96 offen offset:3072 nt lds
    s_add_u32 m0, m0, 4096
    s_add_u32 s96, s96, s63
    s_sub_u32 s97, s97, 1
    s_cmp_lg_u32 s97, 0
    s_cbranch_scc1 L_seg_13
    s_sub_u32 s7, s13, 36
    v_add_u32 v23, s7, v21
    s_waitcnt vmcnt(32)
    v_max_i32 v24, v24, v23
    ds_write_b32 v20, v24
    v_add_u32 v23, 8, v23
    s_waitcnt vmcnt(24)
    v_max_i32 v24, v24, v23
    ds_write_b32 v20, v24
    v_add_u32 v23, 6, v23
    s_waitcnt vmcnt(18)
    v_max_i32 v24, v24, v23
    ds_write_b32 v20, v24
    v_add_u32 v23, 2, v23
    s_waitcnt vmcnt(16)
    v_max_i32 v24, v24, v23
    ds_write_b32 v20, v24
    v_add_u32 v23, 2, v23
    s_waitcnt vmcnt(14)
    v_max_i32 v24, v24, v23
    ds_write_b32 v20, v24
    v_add_u32 v23, 2, v23
    s_waitcnt vmcnt(12)
    v_max_i32 v24, v24, v23
    ds_write_b32 v20, v24
    v_add_u32 v23, 2, v23
    s_waitcnt vmcnt(10)
    v_max_i32 v24, v24, v23
    ds_write_b32 v20, v24
    v_add_u32 v23, 2, v23
    s_waitcnt vmcnt(8)
    v_max_i32 v24, v24, v23
    ds_write_b32 v20, v24
    v_add_u32 v23, 2, v23
    s_waitcnt vmcnt(6)
    v_max_i32 v24, v24, v23
    ds_write_b32 v20, v24
    v_add_u32 v23, 2, v23
    s_waitcnt vmcnt(4)
    v_max_i32 v24, v24, v23
    ds_write_b32 v20, v24
    v_add_u32 v23, 2, v23
    s_waitcnt vmcnt(2)
    v_max_i32 v24, v24, v23
    ds_write_b32 v20, v24
    v_add_u32 v23, 2, v23
    s_waitcnt vmcnt(0)
    v_max_i32 v24, v24, v23
    ds_write_b32 v20, v24
    s_waitcnt lgkmcnt(0)
    s_endpgm
L_pad3:
    s_branch L_padret
L_S_ldo:
L_ldO:
    v_mov_b32 v21, -7
    s_mov_b32 s96, s61
    s_mov_b32 m0, 36864
    s_mov_b32 s97, 8
L_seg_15:
    s_waitcnt vmcnt(25)
    buffer_load_dwordx4 v14, s[48:51], s96 offen offset:0 nt lds
    v_max_i32 v24, v24, v21
    buffer_load_dwordx4 v15, s[48:51], s96 offen offset:1024 nt lds
    ds_write_b32 v20, v24
    v_add_u32 v21, 4, v21
    buffer_load_dwordx4 v16, s[48:51], s96 offen offset:2048 nt lds
    buffer_load_dwordx4 v17, s[48:51], s96 offen offset:3072 nt lds
    s_add_u32 m0, m0, 4096
    s_add_u32 s96, s96, 32768
    s_sub_u32 s97, s97, 1
    s_cmp_lg_u32 s97, 0
    s_cbranch_scc1 L_seg_15
    s_mov_b32 s96, s61
    s_mov_b32 m0, 69632
    s_mov_b32 s97, 8
L_seg_16:
    s_waitcnt vmcnt(25)
    buffer_load_dwordx4 v12, s[52:55], s96 offen offset:0 nt lds
    v_max_i32 v24, v24, v21
    buffer_load_dwordx4 v12, s[52:55], s96 offen offset:1024 nt lds
    ds_write_b32 v20, v24
    v_add_u32 v21, 4, v21
    buffer_load_dwordx4 v13, s[52:55], s96 offen offset:2048 nt lds
    buffer_load_dwordx4 v13, s[52:55], s96 offen offset:3072 nt lds
    s_add_u32 m0, m0, 4096
    s_add_u32 s96, s96, 32768
    s_sub_u32 s97, s97, 1
    s_cmp_lg_u32 s97, 0
    s_cbranch_scc1 L_seg_16
    s_mov_b32 s96, s62
    s_mov_b32 m0, 102400
    s_mov_b32 s97, s15
L_seg_17:
    s_waitcnt vmcnt(25)
    buffer_load_dwordx4 v18, s[56:59], s96 offen offset:0 nt lds
    v_max_i32 v24, v24, v21
    buffer_load_dwordx4 v19, s[56:59], s96 offen offset:1024 nt lds
    ds_write_b32 v20, v24
    v_add_u32 v21, 4, v21
    buffer_load_dwordx4 v28, s[56:59], s96 offen offset:2048 nt lds
    buffer_load_dwordx4 v29, s[56:59], s96 offen offset:3072 nt lds
    s_add_u32 m0, m0, 4096
    s_add_u32 s96, s96, s63
    s_sub_u32 s97, s97, 1
    s_cmp_lg_u32 s97, 0
    s_cbranch_scc1 L_seg_17
    s_mov_b64 s[44:45], s[32:33]
    s_mov_b32 s96, s60
    s_mov_b32 m0, 18432
    s_waitcnt vmcnt(25)
    buffer_load_dwordx4 v10, s[44:47], s96 offen offset:0 nt lds
    v_max_i32 v24, v24, v21
    buffer_load_dwordx4 v25, s[44:47], s96 offen offset:1024 nt lds
    ds_write_b32 v20, v24
    v_add_u32 v21, 4, v21
    buffer_load_dwordx4 v26, s[44:47], s96 offen offset:2048 nt lds
    buffer_load_dwordx4 v27, s[44:47], s96 offen offset:3072 nt lds
    s_add_u32 m0, m0, 4096
    s_add_u32 s96, s96, 131072
    s_waitcnt vmcnt(25)
    buffer_load_dwordx4 v10, s[44:47], s96 offen offset:0 nt lds
    v_max_i32 v24, v24, v21
    buffer_load_dwordx4 v25, s[44:47], s96 offen offset:1024 nt lds
    ds_write_b32 v20, v24
    v_add_u32 v21, 4, v21
    buffer_load_dwordx4 v26, s[44:47], s96 offen offset:2048 nt lds
    buffer_load_dwordx4 v27, s[44:47], s96 offen offset:3072 nt lds
    s_add_u32 m0, m0, 4096
    s_add_u32 s96, s96, 131072
    s_waitcnt vmcnt(25)
    buffer_load_dwordx4 v10, s[44:47], s96 offen offset:0 nt lds
    v_max_i32 v24, v24, v21
    buffer_load_dwordx4 v25, s[44:47], s96 offen offset:1024 nt lds
    ds_write_b32 v20, v24
    v_add_u32 v21, 4, v21
    buffer_load_dwordx4 v26, s[44:47], s96 offen offset:2048 nt lds
    buffer_load_dwordx4 v27, s[44:47], s96 offen offset:3072 nt lds
    s_add_u32 m0, m0, 4096
    s_add_u32 s96, s96, 131072
    s_waitcnt vmcnt(25)
    buffer_load_dwordx4 v10, s[44:47], s96 offen offset:0 nt lds
    v_max_i32 v24, v24, v21
    buffer_load_dwordx4 v25, s[44:47], s96 offen offset:1024 nt lds
    ds_write_b32 v20, v24
    v_add_u32 v21, 4, v21
    buffer_load_dwordx4 v26, s[44:47], s96 offen offset:2048 nt lds
    buffer_load_dwordx4 v27, s[44:47], s96 offen offset:3072 nt lds
    s_add_u32 m0, m0, 2048
    s_add_u32 s96, s96, 65536
    s_waitcnt vmcnt(25)
    buffer_load_dwordx4 v26, s[44:47], s96 offen offset:2048 nt lds
    v_max_i32 v24, v24, v21
    buffer_load_dwordx4 v27, s[44:47], s96 offen offset:3072 nt lds
    ds_write_b32 v20, v24
    v_add_u32 v21, 2, v21
L_wc_18:
    ds_read_b32 v23, v22
    s_waitcnt lgkmcnt(0)
    v_cmp_gt_i32 vcc, 1, v23
    s_cbranch_vccnz L_rt_19
    s_mov_b64 s[48:49], s[28:29]
    s_mov_b32 s96, s61
    s_mov_b32 m0, 36864
    s_mov_b32 s97, 8
L_seg_20:
    s_waitcnt vmcnt(25)
    buffer_load_dwordx4 v14, s[48:51], s96 offen offset:0 nt lds
    v_max_i32 v24, v24, v21
    buffer_load_dwordx4 v15, s[48:51], s96 offen offset:1024 nt lds
    ds_write_b32 v20, v24
    v_add_u32 v21, 4, v21
    buffer_load_dwordx4 v16, s[48:51], s96 offen offset:2048 nt lds
    buffer_load_dwordx4 v17, s[48:51], s96 offen offset:3072 nt lds
    s_add_u32 m0, m0, 4096
    s_add_u32 s96, s96, 32768
    s_sub_u32 s97, s97, 1
    s_cmp_lg_u32 s97, 0
    s_cbranch_scc1 L_seg_20
L_wc_21:
    ds_read_b32 v23, v22
    s_waitcnt lgkmcnt(0)
    v_cmp_gt_i32 vcc, 2, v23
    s_cbranch_vccnz L_rt_22
    s_waitcnt lgkmcnt(0)
    ds_read_b32 v23, v22
    v_add_u32 v21, 0, v21
    s_mov_b32 s13, 29
    s_mov_b64 s[52:53], s[30:31]
    s_mov_b32 s96, s61
    s_mov_b32 m0, 69632
    s_mov_b32 s97, 8
L_seg_23:
    s_waitcnt vmcnt(25) lgkmcnt(0)
    v_subrev_u32 v23, 2, v23
    v_cmp_gt_u32 vcc, 2, v23
    s_cbranch_vccz L_ad_24
    s_waitcnt vmcnt(9)
    v_add_u32 v23, 16, v21
    v_max_i32 v24, v24, v23
L_ad_24:
    buffer_load_dwordx4 v12, s[52:55], s96 offen offset:0 nt lds
    v_max_i32 v24, v24, v21
    buffer_load_dwordx4 v12, s[52:55], s96 offen offset:1024 nt lds
    ds_write_b32 v20, v24
    v_add_u32 v21, 4, v21
    buffer_load_dwordx4 v13, s[52:55], s96 offen offset:2048 nt lds
    buffer_load_dwordx4 v13, s[52:55], s96 offen offset:3072 nt lds
    ds_read_b32 v23, v22
    s_add_u32 m0, m0, 4096
    s_add_u32 s96, s96, 32768
    s_sub_u32 s97, s97, 1
    s_cmp_lg_u32 s97, 0
    s_cbranch_scc1 L_seg_23
L_wc_25:
    ds_read_b32 v23, v22
    s_waitcnt lgkmcnt(0)
    v_cmp_gt_i32 vcc, 4, v23
    s_cbranch_vccnz L_rt_26
    v_add_u32 v21, 0, v21
    s_mov_b64 s[56:57], s[34:35]
    s_mov_b32 s96, s62
    s_mov_b32 m0, 102400
    s_mov_b32 s97, s15
L_seg_27:
    s_waitcnt vmcnt(25)
    buffer_load_dwordx4 v18, s[56:59], s96 offen offset:0 nt lds
    v_max_i32 v24, v24, v21
    buffer_load_dwordx4 v19, s[56:59], s96 offen offset:1024 nt lds
    ds_write_b32 v20, v24
    v_add_u32 v21, 4, v21
    buffer_load_dwordx4 v28, s[56:59], s96 offen offset:2048 nt lds
    buffer_load_dwordx4 v29, s[56:59], s96 offen offset:3072 nt lds
    s_add_u32 m0, m0, 4096
    s_add_u32 s96, s96, s63
    s_sub_u32 s97, s97, 1
    s_cmp_lg_u32 s97, 0
    s_cbranch_scc1 L_seg_27
    v_add_u32 v23, 1, v21
    s_waitcnt vmcnt(24)
    v_max_i32 v24, v24, v23
    ds_write_b32 v20, v24
    v_add_u32 v23, 6, v23
    s_waitcnt vmcnt(18)
    v_max_i32 v24, v24, v23
    ds_write_b32 v20, v24
    v_add_u32 v23, 2, v23
    s_waitcnt vmcnt(16)
    v_max_i32 v24, v24, v23
    ds_write_b32 v20, v24
    v_add_u32 v23, 2, v23
    s_waitcnt vmcnt(14)
    v_max_i32 v24, v24, v23
    ds_write_b32 v20, v24
    v_add_u32 v23, 2, v23
    s_waitcnt vmcnt(12)
    v_max_i32 v24, v24, v23
    ds_write_b32 v20, v24
    v_add_u32 v23, 2, v23
    s_waitcnt vmcnt(10)
    v_max_i32 v24, v24, v23
    ds_write_b32 v20, v24
    v_add_u32 v23, 2, v23
    s_waitcnt vmcnt(8)
    v_max_i32 v24, v24, v23
    ds_write_b32 v20, v24
    v_add_u32 v23, 2, v23
    s_waitcnt vmcnt(6)
    v_max_i32 v24, v24, v23
    ds_write_b32 v20, v24
    v_add_u32 v23, 2, v23
    s_waitcnt vmcnt(4)
    v_max_i32 v24, v24, v23
    ds_write_b32 v20, v24
    v_add_u32 v23, 2, v23
    s_waitcnt vmcnt(2)
    v_max_i32 v24, v24, v23
    ds_write_b32 v20, v24
    v_add_u32 v23, 2, v23
    s_waitcnt vmcnt(0)
    v_max_i32 v24, v24, v23
    ds_write_b32 v20, v24
    s_waitcnt lgkmcnt(0)
    s_endpgm
L_S_hloop:
L_hx:
    ds_read_b128 v[28:31], v24
    v_mov_b32 v34, s18
    s_waitcnt lgkmcnt(0)
    v_cmp_u_f32 vcc, v28, v31
    v_dot2_f32_bf16 v32, v28, v28, 0
    s_cbranch_vccnz L_rt_29
    v_dot2_f32_bf16 v33, v28, s55, 0
    v_dot2_f32_bf16 v32, v29, v29, v32
    v_dot2_f32_bf16 v33, v29, s55, v33
    v_dot2_f32_bf16 v32, v30, v30, v32
    v_dot2_f32_bf16 v33, v30, s55, v33
    v_dot2_f32_bf16 v32, v31, v31, v32
    v_dot2_f32_bf16 v33, v31, s55, v33
    s_nop 1
    v_add_f32_dpp v32, v32, v32 quad_perm:[1,0,3,2] row_mask:0xf bank_mask:0xf
    v_add_f32_dpp v33, v33, v33 quad_perm:[1,0,3,2] row_mask:0xf bank_mask:0xf
    s_nop 0
    v_add_f32_dpp v32, v32, v32 quad_perm:[2,3,0,1] row_mask:0xf bank_mask:0xf
    v_add_f32_dpp v33, v33, v33 quad_perm:[2,3,0,1] row_mask:0xf bank_mask:0xf
    s_nop 0
    v_add_f32_dpp v32, v32, v32 row_half_mirror row_mask:0xf bank_mask:0xf
    v_add_f32_dpp v33, v33, v33 row_half_mirror row_mask:0xf bank_mask:0xf
    s_nop 0
    v_add_f32_dpp v32, v32, v32 row_ror:8 row_mask:0xf bank_mask:0xf
    v_add_f32_dpp v33, v33, v33 row_ror:8 row_mask:0xf bank_mask:0xf
    s_cmp_eq_u32 s58, 0
    v_cmp_u_f32 vcc, v33, v33
    s_cbranch_vccnz L_rt_30
    s_mov_b64 exec, s[20:21]
    s_cbranch_scc1 L_sl_31
    buffer_store_dwordx3 v[32:34], v1, s[8:11], s56 offen
L_sd_32:
    s_mov_b64 exec, s[22:23]
    s_sleep 2
    buffer_load_dwordx3 v[36:38], v22, s[8:11], s47 offen sc1
    s_sleep 1
    buffer_load_dwordx3 v[40:42], v22, s[8:11], s47 offen sc1
L_hp:
    s_waitcnt vmcnt(1)
    v_cmp_ne_u32 vcc, s18, v38
    v_add_f32_dpp v32, v36, v36 quad_perm:[1,0,3,2] row_mask:0xf bank_mask:0xf
    v_add_f32_dpp v33, v37, v37 quad_perm:[1,0,3,2] row_mask:0xf bank_mask:0xf
    s_cbranch_vccz L_hpd
    s_cmp_eq_u32 s42, 0
    s_cbranch_scc0 L_hps
    s_sleep 2
L_hps:
    buffer_load_dwordx3 v[36:38], v22, s[8:11], s47 offen sc1
    s_waitcnt vmcnt(1)
    v_cmp_ne_u32 vcc, s18, v42
    v_add_f32_dpp v32, v40, v40 quad_perm:[1,0,3,2] row_mask:0xf bank_mask:0xf
    v_add_f32_dpp v33, v41, v41 quad_perm:[1,0,3,2] row_mask:0xf bank_mask:0xf
    s_cbranch_vccz L_hpd
    buffer_load_dwordx3 v[40:42], v22, s[8:11], s47 offen sc1
    s_sub_u32 s43, s43, 1
    s_cbranch_scc0 L_hp
    s_endpgm
L_hpd:
    v_add_f32_dpp v32, v32, v32 quad_perm:[2,3,0,1] row_mask:0xf bank_mask:0xf
    v_add_f32_dpp v33, v33, v33 quad_perm:[2,3,0,1] row_mask:0xf bank_mask:0xf
    s_nop 0
    v_add_f32_dpp v32, v32, v32 row_half_mirror row_mask:0xf bank_mask:0xf
    v_add_f32_dpp v33, v33, v33 row_half_mirror row_mask:0xf bank_mask:0xf
    v_mul_f32 v33, s100, v33
    v_fma_f32 v32, v32, s100, v19
    v_fma_f32 v32, -v33, v33, v32
    v_max_f32 v32, v19, v32
    v_rsq_f32 v32, v32
    v_mul_f32 v33, s101, v33
    v_mul_f32 v33, -v33, v32
    v_mul_f32 v32, s101, v32
    ds_write_b64 v26, v[32:33]
    s_mov_b64 s[20:21], 1
    s_mov_b64 s[22:23], -1
    s_mov_b64 exec, -1
    s_cmp_eq_u32 s42, 0
    s_cbranch_scc1 L_hg
    s_barrier
L_hm:
    ds_read_b32 v28, v25
    s_waitcnt lgkmcnt(0)
    v_cmp_u_f32 vcc, v28, v28
    s_cbranch_vccnz L_rt_33
    s_sleep 2
    buffer_load_dwordx4 v[44:47], v1, s[8:11], s51 offen offset:0 sc1
    buffer_load_dwordx4 v[48:51], v1, s[8:11], s51 offen offset:1024 sc1
    s_sleep 2
    buffer_load_dwordx4 v[44:47], v1, s[8:11], s51 offen offset:0 sc1
    buffer_load_dwordx4 v[48:51], v1, s[8:11], s51 offen offset:1024 sc1
L_hq:
    s_waitcnt vmcnt(2)
    v_pk_add_f32 v[28:29], v[44:45], v[46:47]
    v_pk_add_f32 v[30:31], v[48:49], v[50:51]
    v_pk_add_f32 v[28:29], v[28:29], v[30:31]
    v_max3_f32 v32, v44, v46, v48
    v_cmp_u_f32 vcc, v28, v29
    v_max_f32 v32, v32, v50
    s_cbranch_vccnz L_rt_35
    s_nop 0
    v_max_f32_dpp v32, v32, v32 quad_perm:[1,0,3,2] row_mask:0xf bank_mask:0xf
    s_nop 1
    v_max_f32_dpp v33, v32, v32 quad_perm:[2,3,0,1] row_mask:0xf bank_mask:0xf
    s_nop 1
    v_max_f32_dpp v33, v33, v33 row_half_mirror row_mask:0xf bank_mask:0xf
    s_nop 1
    v_max_f32_dpp v33, v33, v33 row_ror:8 row_mask:0xf bank_mask:0xf
    v_sub_f32 v28, v44, v33
    v_sub_f32 v29, v46, v33
    v_sub_f32 v30, v48, v33
    v_sub_f32 v31, v50, v33
    v_exp_f32 v28, v28
    v_exp_f32 v29, v29
    v_exp_f32 v30, v30
    v_exp_f32 v31, v31
    v_sub_f32 v32, v32, v33
    v_mul_f32 v34, v45, v28
    v_mul_f32 v35, v47, v29
    v_fmac_f32 v34, v49, v30
    v_fmac_f32 v35, v51, v31
    v_add_f32 v29, v34, v35
    v_exp_f32 v28, v32
    s_nop 0
    v_add_f32_dpp v29, v29, v29 quad_perm:[1,0,3,2] row_mask:0xf bank_mask:0xf
    s_nop 1
    v_add_f32_dpp v29, v29, v29 quad_perm:[2,3,0,1] row_mask:0xf bank_mask:0xf
    s_nop 1
    v_add_f32_dpp v29, v29, v29 row_half_mirror row_mask:0xf bank_mask:0xf
    s_nop 1
    v_add_f32_dpp v29, v29, v29 row_ror:8 row_mask:0xf bank_mask:0xf
    v_rcp_f32 v29, v29
    s_add_u32 s51, s51, 2048
    v_mul_f32 v28, v28, v29
    ds_write_b32 v27, v28
    s_add_u32 s18, s18, 0x07050301
    s_and_b32 s18, s18, 0x7f7f7f7f
    v_add_u32 v24, 5760, v24
    v_add_u32 v25, 5760, v25
    v_add_u32 v26, 5760, v26
    v_add_u32 v27, 5760, v27
    s_cmp_eq_u32 s42, 3
    s_cbranch_scc1 L_hend
    s_cmp_eq_u32 s42, 0
    s_cbranch_scc1 L_hw1
    s_barrier
L_hw2:
    s_add_u32 s42, s42, 1
    s_barrier
    s_branch L_hx
L_hw1:
    s_setprio 3
    s_branch L_hw2
L_hend:
    s_waitcnt vmcnt(0) lgkmcnt(0)
    s_endpgm
L_rt_29:
    s_sub_u32 s43, s43, 1
    s_cbranch_scc0 L_hx
    s_endpgm
L_rt_30:
    s_sub_u32 s43, s43, 1
    s_cbranch_scc0 L_hx
    s_endpgm
L_hg:
    ds_read_b32 v28, v18 offset:4
    s_sleep 2
    s_sub_u32 s43, s43, 1
    s_cbranch_scc1 L_end
    s_waitcnt lgkmcnt(0)
    v_cmp_gt_i32 vcc, 0, v28
    s_cbranch_vccnz L_hg
    s_branch L_hg2
L_rt_33:
    s_cmp_eq_u32 s42, 0
    s_cbranch_scc0 L_rs_34
    s_sleep 2
L_rs_34:
    s_sub_u32 s43, s43, 1
    s_cbranch_scc0 L_hm
    s_endpgm
L_hg2:
    buffer_load_dwordx4 v[44:47], v1, s[8:11], s51 offen offset:0 sc1
    buffer_load_dwordx4 v[48:51], v1, s[8:11], s51 offen offset:1024 sc1
    s_waitcnt vmcnt(0)
    s_branch L_hq
L_rt_35:
    s_cmp_eq_u32 s42, 0
    s_cbranch_scc0 L_hqs
    s_sleep 2
L_hqs:
    s_mov_b64 exec, vcc
    buffer_load_dwordx4 v[44:47], v1, s[8:11], s51 offen offset:0 sc1
    buffer_load_dwordx4 v[48:51], v1, s[8:11], s51 offen offset:1024 sc1
    s_mov_b64 exec, -1
    s_cmp_eq_u32 s42, 0
    s_cbranch_scc0 L_hqt
    s_waitcnt vmcnt(0)
L_hqt:
    s_sub_u32 s43, s43, 1
    s_cbranch_scc0 L_hq
    s_endpgm
L_ePG2:
    .p2align 12
L_PG2:
L_pad4:
    s_branch L_padret
L_S_hot:
L_P1_0:
    s_waitcnt vmcnt(0)
    s_cmp_lt_u32 s6, 5
    s_cbranch_scc0 L_sk_37
    s_sleep 4
    buffer_load_dwordx4 v[128:131], v1, s[8:11], s24 offen sc1
    buffer_load_dwordx4 v[132:135], v1, s[8:11], s24 offen offset:1024 sc1
L_sk_37:
    s_add_u32 s18, s18, 0x07050301
    s_and_b32 s18, s18, 0x7f7f7f7f
    ds_read_b64_tr_b16 v[112:113], v5 offset:10240
    ds_read_b64_tr_b16 v[114:115], v5 offset:11264
    ds_read_b64_tr_b16 v[104:105], v5 offset:0
    ds_read_b64_tr_b16 v[106:107], v5 offset:1024
    ds_read_b64_tr_b16 v[108:109], v5 offset:8192
    ds_read_b64_tr_b16 v[110:111], v5 offset:9216
    s_cmp_lt_u32 s6, 5
    s_cbranch_scc0 L_P1e_0
L_P1w_0:
    s_waitcnt vmcnt(0)
    v_bitop3_b32 v136, v128, v132, v7 bitop3:0x7e
    v_and_b32 v128, 0xffffff00, v128
    v_and_b32 v132, 0xffffff00, v132
    v_pk_add_f32 v[130:131], v[130:131], v[134:135]
    v_pk_add_f32 v[128:129], v[128:129], v[132:133]
    v_cmp_ne_u32_sdwa vcc, v136, 0 src0_sel:BYTE_0 src1_sel:DWORD
    v_permlane32_swap_b32 v130, v131
    s_cbranch_vccnz L_rt_38
    v_permlane32_swap_b32 v128, v129
    v_add_f32 v130, v130, v131
    v_add_f32 v128, v128, v129
    s_nop 1
    v_permlane16_swap_b32 v128, v130
    v_add_f32 v128, v128, v130
    s_nop 1
    v_add_f32_dpp v128, v128, v128 row_ror:8 row_mask:0xf bank_mask:0xf
    v_add_f32 v2, v128, v2
    v_cvt_pk_bf16_f32 v129, v2, v2
    ds_write_b16 v3, v129 offset:0
L_P1e_0:
    s_barrier
L_P2_0:
    ds_read_b128 v[132:135], v152 offset:0
    ds_read_b128 v[128:131], v4 offset:0
    v_perm_b32 v7, s18, s18, v164
    s_waitcnt lgkmcnt(1)
    v_mfma_f32_16x16x32_bf16 v[136:139], v[132:135], v[112:115], 0
    s_waitcnt lgkmcnt(0)
    v_smfmac_f32_16x16x64_bf16 v[136:139], v[128:131], v[104:111], v165
    v_fma_f32 v148, v128, v131, v132
    v_cmp_u_f32 vcc, v148, v148
    s_cbranch_vccnz L_rt_40
    s_cmp_eq_u32 s58, 0
    s_nop 3
    v_add_f32 v136, v136, v138
    v_cmp_u_f32 vcc, v136, v136
    v_mov_b32_sdwa v136, v7 dst_sel:BYTE_0 dst_unused:UNUSED_PRESERVE src0_sel:BYTE_2
    s_cbranch_vccnz L_rt_41
    s_cbranch_scc1 L_sl_42
    buffer_store_dword v136, v6, s[8:11], s60 offen
L_sd_43:
    v_mov_b64 v[140:141], 0
    v_mov_b64 v[142:143], 0
    v_mov_b64 v[112:113], 0
    v_mov_b64 v[118:119], 0
    s_cmp_eq_u32 s42, 0
    s_cbranch_scc1 L_P3z_0
    s_waitcnt vmcnt(0)
    buffer_load_dwordx4 v[120:123], v1, s[8:11], s62 offen sc1
    s_sleep 1
L_P3j_0:
    buffer_load_dwordx4 v[124:127], v1, s[8:11], s62 offen sc1
L_P3l_0:
    s_waitcnt vmcnt(1)
    v_cmp_ne_u32_sdwa vcc, v120, v7 src0_sel:BYTE_0 src1_sel:BYTE_0
    v_mov_b64 v[130:131], v[122:123]
    v_and_b32 v128, 0xffffff00, v120
    v_mov_b32 v129, v121
    s_cbranch_vccnz L_P3r_0
L_P3d_0:
    s_mov_b64 exec, -1
    v_permlane32_swap_b32 v130, v131
    v_permlane32_swap_b32 v128, v129
    v_add_f32 v130, v130, v131
    v_add_f32 v128, v128, v129
    s_nop 1
    v_permlane16_swap_b32 v128, v130
    v_add_f32 v128, v128, v130
    s_nop 1
    v_add_f32_dpp v128, v128, v128 row_ror:8 row_mask:0xf bank_mask:0xf
    v_cvt_pk_bf16_f32 v129, v128, v128
    ds_write_b16 v153, v129 offset:0
    s_barrier
L_P4_0:
    ds_read_b128 v[128:131], v154 offset:0
    ds_read_b128 v[132:135], v154 offset:128
    ds_read_b64 v[150:151], v160 offset:0
    s_waitcnt lgkmcnt(1)
    v_cmp_u_f32 vcc, v128, v132
    s_cbranch_vccnz L_rt_52
    v_smfmac_f32_16x16x64_bf16 v[140:143], v[128:131], v[8:15], v165
    v_smfmac_f32_16x16x64_bf16 v[140:143], v[132:135], v[16:23], v165
L_P4a_0:
    s_waitcnt lgkmcnt(0)
    v_cmp_u_f32 vcc, v150, v151
    s_cbranch_vccnz L_rt_53
    s_nop 4
    v_pk_add_f32 v[140:141], v[140:141], v[142:143]
    v_mul_f32 v136, v151, v141
    v_fmac_f32 v136, v150, v140
    v_cmp_u_f32 vcc, v136, v136
    s_nop 0
    v_max_f32_dpp v138, v136, v136 quad_perm:[1,0,3,2] row_mask:0xf bank_mask:0xf
    s_cbranch_vccnz L_rt_54
    s_nop 0
    v_max_f32_dpp v138, v138, v138 quad_perm:[2,3,0,1] row_mask:0xf bank_mask:0xf
    s_cmp_eq_u32 s42, 0
    s_nop 0
    v_max_f32_dpp v138, v138, v138 row_half_mirror row_mask:0xf bank_mask:0xf
    s_nop 1
    v_max_f32_dpp v138, v138, v138 row_ror:8 row_mask:0xf bank_mask:0xf
    v_sub_f32 v139, v136, v138
    v_exp_f32 v139, v139
    ds_write_b32 v156, v138 offset:0
    v_cvt_pk_bf16_f32 v137, v139, v139
    ds_write_b16 v155, v137 offset:0
    s_cbranch_scc1 L_P5z
L_P5y:
    ds_read_b128 v[128:131], v157 offset:0
    ds_read_b32 v132, v158 offset:0
    v_add_f32_dpp v139, v139, v139 quad_perm:[1,0,3,2] row_mask:0xf bank_mask:0xf
    s_nop 1
    v_add_f32_dpp v139, v139, v139 quad_perm:[2,3,0,1] row_mask:0xf bank_mask:0xf
    s_cmp_eq_u32 s58, 0
    s_nop 0
    v_add_f32_dpp v139, v139, v139 row_half_mirror row_mask:0xf bank_mask:0xf
    s_nop 1
    v_add_f32_dpp v139, v139, v139 row_ror:8 row_mask:0xf bank_mask:0xf
    s_mov_b64 exec, 0x10001
    s_cbranch_scc1 L_sl_55
    buffer_store_dwordx2 v[138:139], v1, s[8:11], s27 offen offset:0
L_sd_56:
    s_mov_b64 exec, -1
L_P5_0:
    s_waitcnt lgkmcnt(1)
    v_cmp_u_f32 vcc, v128, v131
    s_cbranch_vccnz L_rt_60
    v_smfmac_f32_16x16x64_bf16 v[112:115], v[128:131], v[24:31], v165 abid:1
    s_waitcnt lgkmcnt(0)
    v_max_f32_dpp v133, v132, v132 quad_perm:[1,0,3,2] row_mask:0xf bank_mask:0xf
    v_smfmac_f32_16x16x64_bf16 v[116:119], v[128:131], v[32:39], v165 abid:1
    s_nop 0
    v_max_f32_dpp v133, v133, v133 quad_perm:[2,3,0,1] row_mask:0xf bank_mask:0xf
    s_cmp_eq_u32 s58, 0
    s_nop 0
    v_max_f32_dpp v133, v133, v133 row_half_mirror row_mask:0xf bank_mask:0xf
    v_sub_f32 v134, v132, v133
    v_exp_f32 v134, v134
    s_nop 1
    v_mul_f32_dpp v135, v134, v112 row_newbcast:0 row_mask:0xf bank_mask:0xf
    v_mul_f32_dpp v136, v134, v113 row_newbcast:1 row_mask:0xf bank_mask:0xf
    s_nop 0
    v_fmac_f32_dpp v135, v134, v118 row_newbcast:2 row_mask:0xf bank_mask:0xf
    v_fmac_f32_dpp v136, v134, v119 row_newbcast:3 row_mask:0xf bank_mask:0xf
    v_add_f32 v137, v135, v136
    v_add_f32 v135, v135, v136
    s_nop 1
    v_permlane16_swap_b32 v135, v137
    v_add_f32 v135, v135, v137
    v_cvt_pk_bf16_f32 v136, v135, v135
    s_cbranch_scc1 L_sl_61
    buffer_store_short v136, v159, s[8:11], s60 offen
L_sd_62:
    v_cmp_u_f32 vcc, v135, v135
    s_cbranch_vccnz L_rt_63
    v_mov_b32 v141, -1
    v_add_u32 v140, s28, v1
    s_cmp_eq_u32 s57, 32
    s_cbranch_scc1 L_P6s_0_4
L_P6s_0_2:
    s_cmp_eq_u32 s42, 0
    s_cbranch_scc1 L_P6z_0_2
    s_sleep 2
L_P6_0_2:
    buffer_load_dwordx4 v[104:107], v1, s[8:11], s21 offen offset:0 sc1
    s_sleep 2
L_P6j_0_2:
    buffer_load_dwordx4 v[104:107], v1, s[8:11], s21 offen offset:0 sc1
L_P6l_0_2:
    ds_read_b128 v[144:147], v160 offset:128
    s_waitcnt vmcnt(1)
    v_cmp_u_f32 vcc, v104, v107
    s_cbranch_vccnz L_rt_64
L_P6d_0_2:
    ds_read_b128 v[144:147], v160 offset:128
    v_mfma_f32_16x16x32_bf16 v[112:115], v[104:107], v[72:75], 0
    v_mfma_f32_16x16x32_bf16 v[116:119], v[104:107], v[76:79], 0
    s_waitcnt lgkmcnt(1)
    v_cmp_u_f32 vcc, v144, v147
    s_cbranch_vccnz L_P6w_0_2
L_P6y_0_2:
    s_nop 3
    v_pk_mul_f32 v[112:113], v[112:113], v[144:145]
    v_pk_mul_f32 v[116:117], v[116:117], v[144:145]
    v_pk_fma_f32 v[112:113], v[114:115], v[146:147], v[112:113]
    v_pk_fma_f32 v[116:117], v[118:119], v[146:147], v[116:117]
    v_add_f32 v148, v112, v113
    v_add_f32 v149, v116, v117
    v_cmp_u_f32 vcc, v148, v149
    s_cmp_eq_u32 s42, 0
    v_permlane16_swap_b32 v148, v149
    v_add_f32 v148, v148, v149
    ds_write_b32 v163, v148 offset:0
    s_cbranch_vccnz L_rt_65
    s_cbranch_scc1 L_P6b_0_2
    s_barrier
L_P6b_0_2:
    ds_read_b128 v[128:131], v140 offset:0
    s_cmp_eq_u32 s58, 0
    s_cbranch_scc1 L_sl_66
    buffer_store_short v141, v159, s[8:11], s20 offen
L_sd_67:
L_RD_0_2:
    s_waitcnt lgkmcnt(0)
    v_pk_add_f32 v[128:129], v[128:129], v[130:131]
    v_add_f32 v130, v128, v129
    v_add_f32 v128, v128, v129
    s_nop 1
    v_permlane32_swap_b32 v128, v130
    v_add_f32 v128, v128, v130
    v_cmp_u_f32 vcc, v128, v128
    v_mov_b32_sdwa v128, v7 dst_sel:BYTE_0 dst_unused:UNUSED_PRESERVE src0_sel:BYTE_2
    s_cbranch_vccnz L_rt_68
    buffer_store_dword v128, v161, s[8:11], s25 offen sc1
L_P6f_0:
L_P1_1:
    s_cmp_eq_u32 s42, 0
    s_cbranch_scc1 L_sg_86
L_sg_87:
    s_waitcnt vmcnt(0)
    s_cmp_lt_u32 s6, 5
    s_cbranch_scc0 L_sk_100
    s_cmp_eq_u32 s42, 0
    s_cbranch_scc1 L_ad1
    s_sleep 2
L_ad1:
    buffer_load_dwordx4 v[128:131], v1, s[8:11], s23 offen sc1
    buffer_load_dwordx4 v[132:135], v1, s[8:11], s23 offen offset:1024 sc1
L_sk_100:
    s_add_u32 s18, s18, 0x07050301
    s_and_b32 s18, s18, 0x7f7f7f7f
    ds_read_b64_tr_b16 v[112:113], v5 offset:28672
    ds_read_b64_tr_b16 v[114:115], v5 offset:29696
    ds_read_b64_tr_b16 v[104:105], v5 offset:18432
    ds_read_b64_tr_b16 v[106:107], v5 offset:19456
    ds_read_b64_tr_b16 v[108:109], v5 offset:26624
    ds_read_b64_tr_b16 v[110:111], v5 offset:27648
    s_cmp_lt_u32 s6, 5
    s_cbranch_scc0 L_P1e_1
L_P1w_1:
    s_waitcnt vmcnt(0)
    v_bitop3_b32 v136, v128, v132, v7 bitop3:0x7e
    v_and_b32 v128, 0xffffff00, v128
    v_and_b32 v132, 0xffffff00, v132
    v_pk_add_f32 v[130:131], v[130:131], v[134:135]
    v_pk_add_f32 v[128:129], v[128:129], v[132:133]
    v_cmp_ne_u32_sdwa vcc, v136, 0 src0_sel:BYTE_0 src1_sel:DWORD
    v_permlane32_swap_b32 v130, v131
    s_cbranch_vccnz L_rt_101
    v_permlane32_swap_b32 v128, v129
    v_add_f32 v130, v130, v131
    v_add_f32 v128, v128, v129
    s_nop 1
    v_permlane16_swap_b32 v128, v130
    v_add_f32 v128, v128, v130
    s_nop 1
    v_add_f32_dpp v128, v128, v128 row_ror:8 row_mask:0xf bank_mask:0xf
    v_add_f32 v2, v128, v2
    v_cvt_pk_bf16_f32 v129, v2, v2
    ds_write_b16 v3, v129 offset:5760
L_P1e_1:
    s_barrier
L_P2_1:
    ds_read_b128 v[132:135], v152 offset:5760
    ds_read_b128 v[128:131], v4 offset:5760
    v_perm_b32 v7, s18, s18, v164
    s_waitcnt lgkmcnt(1)
    v_mfma_f32_16x16x32_bf16 v[136:139], v[132:135], v[112:115], 0
    s_waitcnt lgkmcnt(0)
    v_smfmac_f32_16x16x64_bf16 v[136:139], v[128:131], v[104:111], v165
    v_fma_f32 v148, v128, v131, v132
    v_cmp_u_f32 vcc, v148, v148
    s_cbranch_vccnz L_rt_103
    s_cmp_eq_u32 s58, 0
    s_nop 3
    v_add_f32 v136, v136, v138
    v_cmp_u_f32 vcc, v136, v136
    v_mov_b32_sdwa v136, v7 dst_sel:BYTE_0 dst_unused:UNUSED_PRESERVE src0_sel:BYTE_2
    s_cbranch_vccnz L_rt_104
    s_cbranch_scc1 L_sl_105
    buffer_store_dword v136, v6, s[8:11], s60 offen
L_sd_106:
    v_mov_b64 v[140:141], 0
    v_mov_b64 v[142:143], 0
    v_mov_b64 v[112:113], 0
    v_mov_b64 v[118:119], 0
    s_cmp_eq_u32 s42, 0
    s_cbranch_scc1 L_P3z_1
    s_waitcnt vmcnt(0)
    buffer_load_dwordx4 v[120:123], v1, s[8:11], s62 offen sc1
    s_sleep 1
L_P3j_1:
    buffer_load_dwordx4 v[124:127], v1, s[8:11], s62 offen sc1
L_P3l_1:
    s_waitcnt vmcnt(1)
    v_cmp_ne_u32_sdwa vcc, v120, v7 src0_sel:BYTE_0 src1_sel:BYTE_0
    v_mov_b64 v[130:131], v[122:123]
    v_and_b32 v128, 0xffffff00, v120
    v_mov_b32 v129, v121
    s_cbranch_vccnz L_P3r_1
L_P3d_1:
    s_mov_b64 exec, -1
    v_permlane32_swap_b32 v130, v131
    v_permlane32_swap_b32 v128, v129
    v_add_f32 v130, v130, v131
    v_add_f32 v128, v128, v129
    s_nop 1
    v_permlane16_swap_b32 v128, v130
    v_add_f32 v128, v128, v130
    s_nop 1
    v_add_f32_dpp v128, v128, v128 row_ror:8 row_mask:0xf bank_mask:0xf
    v_cvt_pk_bf16_f32 v129, v128, v128
    ds_write_b16 v153, v129 offset:5760
    s_barrier
L_P4_1:
    ds_read_b128 v[128:131], v154 offset:5760
    ds_read_b128 v[132:135], v154 offset:5888
    ds_read_b64 v[150:151], v160 offset:5760
    s_waitcnt lgkmcnt(1)
    v_cmp_u_f32 vcc, v128, v132
    s_cbranch_vccnz L_rt_114
    v_smfmac_f32_16x16x64_bf16 v[140:143], v[128:131], v[40:47], v165
    v_smfmac_f32_16x16x64_bf16 v[140:143], v[132:135], v[48:55], v165
L_P4a_1:
    s_waitcnt lgkmcnt(0)
    v_cmp_u_f32 vcc, v150, v151
    s_cbranch_vccnz L_rt_115
    s_nop 4
    v_pk_add_f32 v[140:141], v[140:141], v[142:143]
    v_mul_f32 v136, v151, v141
    v_fmac_f32 v136, v150, v140
    v_cmp_u_f32 vcc, v136, v136
    s_nop 0
    v_max_f32_dpp v138, v136, v136 quad_perm:[1,0,3,2] row_mask:0xf bank_mask:0xf
    s_cbranch_vccnz L_rt_116
    s_nop 0
    v_max_f32_dpp v138, v138, v138 quad_perm:[2,3,0,1] row_mask:0xf bank_mask:0xf
    s_nop 1
    v_max_f32_dpp v138, v138, v138 row_half_mirror row_mask:0xf bank_mask:0xf
    s_nop 1
    v_max_f32_dpp v138, v138, v138 row_ror:8 row_mask:0xf bank_mask:0xf
    v_sub_f32 v139, v136, v138
    v_exp_f32 v139, v139
    ds_write_b32 v156, v138 offset:5760
    v_cvt_pk_bf16_f32 v137, v139, v139
    ds_write_b16 v155, v137 offset:5760
    ds_read_b128 v[128:131], v157 offset:5760
    ds_read_b32 v132, v158 offset:5760
    v_add_f32_dpp v139, v139, v139 quad_perm:[1,0,3,2] row_mask:0xf bank_mask:0xf
    s_nop 1
    v_add_f32_dpp v139, v139, v139 quad_perm:[2,3,0,1] row_mask:0xf bank_mask:0xf
    s_cmp_eq_u32 s58, 0
    s_nop 0
    v_add_f32_dpp v139, v139, v139 row_half_mirror row_mask:0xf bank_mask:0xf
    s_nop 1
    v_add_f32_dpp v139, v139, v139 row_ror:8 row_mask:0xf bank_mask:0xf
    s_mov_b64 exec, 0x10001
    s_cbranch_scc1 L_sl_117
    buffer_store_dwordx2 v[138:139], v1, s[8:11], s27 offen offset:2048
L_sd_118:
    s_mov_b64 exec, -1
L_P5_1:
    s_waitcnt lgkmcnt(1)
    v_cmp_u_f32 vcc, v128, v131
    s_cbranch_vccnz L_rt_119
    v_smfmac_f32_16x16x64_bf16 v[112:115], v[128:131], v[56:63], v165 abid:1
    s_waitcnt lgkmcnt(0)
    v_max_f32_dpp v133, v132, v132 quad_perm:[1,0,3,2] row_mask:0xf bank_mask:0xf
    v_smfmac_f32_16x16x64_bf16 v[116:119], v[128:131], v[64:71], v165 abid:1
    s_nop 0
    v_max_f32_dpp v133, v133, v133 quad_perm:[2,3,0,1] row_mask:0xf bank_mask:0xf
    s_cmp_eq_u32 s58, 0
    s_nop 0
    v_max_f32_dpp v133, v133, v133 row_half_mirror row_mask:0xf bank_mask:0xf
    v_sub_f32 v134, v132, v133
    v_exp_f32 v134, v134
    s_nop 1
    v_mul_f32_dpp v135, v134, v112 row_newbcast:0 row_mask:0xf bank_mask:0xf
    v_mul_f32_dpp v136, v134, v113 row_newbcast:1 row_mask:0xf bank_mask:0xf
    s_nop 0
    v_fmac_f32_dpp v135, v134, v118 row_newbcast:2 row_mask:0xf bank_mask:0xf
    v_fmac_f32_dpp v136, v134, v119 row_newbcast:3 row_mask:0xf bank_mask:0xf
    v_add_f32 v137, v135, v136
    v_add_f32 v135, v135, v136
    s_nop 1
    v_permlane16_swap_b32 v135, v137
    v_add_f32 v135, v135, v137
    v_cvt_pk_bf16_f32 v136, v135, v135
    s_cbranch_scc1 L_sl_120
    buffer_store_short v136, v159, s[8:11], s20 offen
L_sd_121:
    v_cmp_u_f32 vcc, v135, v135
    s_cbranch_vccnz L_rt_122
    v_mov_b32 v141, -1
    v_add_u32 v140, s28, v1
    s_cmp_eq_u32 s57, 32
    s_cbranch_scc1 L_P6s_1_4
L_P6s_1_2:
    s_sleep 2
L_P6_1_2:
    buffer_load_dwordx4 v[104:107], v1, s[8:11], s22 offen offset:0 sc1
    s_sleep 2
L_P6j_1_2:
    buffer_load_dwordx4 v[104:107], v1, s[8:11], s22 offen offset:0 sc1
L_P6l_1_2:
    ds_read_b128 v[144:147], v160 offset:5888
    s_waitcnt vmcnt(1)
    v_cmp_u_f32 vcc, v104, v107
    s_cbranch_vccnz L_rt_123
L_P6d_1_2:
    ds_read_b128 v[144:147], v160 offset:5888
    v_mfma_f32_16x16x32_bf16 v[112:115], v[104:107], v[88:91], 0
    v_mfma_f32_16x16x32_bf16 v[116:119], v[104:107], v[92:95], 0
    s_waitcnt lgkmcnt(1)
    v_cmp_u_f32 vcc, v144, v147
    s_cbranch_vccnz L_P6w_1_2
L_P6y_1_2:
    s_nop 3
    v_pk_mul_f32 v[112:113], v[112:113], v[144:145]
    v_pk_mul_f32 v[116:117], v[116:117], v[144:145]
    v_pk_fma_f32 v[112:113], v[114:115], v[146:147], v[112:113]
    v_pk_fma_f32 v[116:117], v[118:119], v[146:147], v[116:117]
    v_add_f32 v148, v112, v113
    v_add_f32 v149, v116, v117
    v_cmp_u_f32 vcc, v148, v149
    s_nop 0
    v_permlane16_swap_b32 v148, v149
    v_add_f32 v148, v148, v149
    ds_write_b32 v163, v148 offset:5760
    s_cbranch_vccnz L_rt_124
    s_barrier
L_P6b_1_2:
    ds_read_b128 v[128:131], v140 offset:5760
    s_mul_i32 s7, s42, s6
    s_cmp_gt_u32 s7, 1
    s_cbranch_scc1 L_P6f_1
    s_cmp_eq_u32 s58, 0
    s_cbranch_scc1 L_sl_125
    buffer_store_short v141, v159, s[8:11], s60 offen
L_sd_126:
L_RD_1_2:
    s_waitcnt lgkmcnt(0)
    v_pk_add_f32 v[128:129], v[128:129], v[130:131]
    v_add_f32 v130, v128, v129
    v_add_f32 v128, v128, v129
    s_nop 1
    v_permlane32_swap_b32 v128, v130
    v_add_f32 v128, v128, v130
    v_cmp_u_f32 vcc, v128, v128
    v_mov_b32_sdwa v128, v7 dst_sel:BYTE_0 dst_unused:UNUSED_PRESERVE src0_sel:BYTE_2
    s_cbranch_vccnz L_rt_127
    buffer_store_dword v128, v161, s[8:11], s26 offen sc1
L_P6f_1:
    s_cmp_eq_u32 s42, 0
    s_cbranch_scc0 L_final
    s_mov_b32 s42, 1
    s_add_u32 s28, s28, 11520
    s_add_u32 s27, s27, 4096
    s_add_u32 s25, s25, 1181696
    s_add_u32 s26, s26, 1181696
    s_add_u32 s23, s23, 1181696
    v_add_u32 v3, 11520, v3
    v_add_u32 v4, 11520, v4
    v_add_u32 v152, 11520, v152
    v_add_u32 v153, 11520, v153
    v_add_u32 v154, 11520, v154
    v_add_u32 v155, 11520, v155
    v_add_u32 v156, 11520, v156
    v_add_u32 v157, 11520, v157
    v_add_u32 v158, 11520, v158
    v_add_u32 v160, 11520, v160
    v_add_u32 v163, 11520, v163
    s_branch L_P1_0
L_pad5:
    s_branch L_padret
L_final:
    s_cmp_lt_u32 s59, 8
    s_cbranch_scc0 L_fin_done
    s_cmp_lt_u32 s6, 5
    s_cbranch_scc0 L_fin_ep
    s_mov_b64 s[52:53], s[36:37]
    s_mov_b32 s54, 2304
    s_mov_b32 s55, 0x20000
    s_add_u32 s24, s24, 1181696
    s_waitcnt lgkmcnt(0)
    s_cmp_lt_u32 s6, 2
    s_cbranch_scc1 L_fs
    s_sleep 2
L_fs:
    s_sleep 6
    s_add_u32 s23, s24, 73856
    buffer_load_dwordx4 v[12:15], v1, s[8:11], s23 offen sc1
    buffer_load_dwordx4 v[16:19], v1, s[8:11], s23 offen offset:1024 sc1
    s_sleep 4
    buffer_load_dwordx4 v[128:131], v1, s[8:11], s24 offen sc1
    buffer_load_dwordx4 v[132:135], v1, s[8:11], s24 offen offset:1024 sc1
L_PF1:
    s_waitcnt vmcnt(2)
    v_bitop3_b32 v20, v12, v16, v7 bitop3:0x7e
    v_and_b32 v12, 0xffffff00, v12
    v_and_b32 v16, 0xffffff00, v16
    v_pk_add_f32 v[14:15], v[14:15], v[18:19]
    v_pk_add_f32 v[12:13], v[12:13], v[16:17]
    v_cmp_ne_u32_sdwa vcc, v20, 0 src0_sel:BYTE_0 src1_sel:DWORD
    v_permlane32_swap_b32 v14, v15
    s_cbranch_vccnz L_rt_133
    v_permlane32_swap_b32 v12, v13
    v_add_f32 v14, v14, v15
    v_add_f32 v12, v12, v13
    s_nop 1
    v_permlane16_swap_b32 v12, v14
    v_add_f32 v12, v12, v14
    s_nop 1
    v_add_f32_dpp v12, v12, v12 row_ror:8 row_mask:0xf bank_mask:0xf
    v_add_f32 v2, v12, v2
    v_cvt_pk_bf16_f32 v13, v2, v2
    buffer_store_short v13, v162, s[52:55], 0 offen
    s_branch L_fin_done
L_PF:
    buffer_load_dwordx4 v[128:131], v1, s[8:11], s24 offen sc1
    buffer_load_dwordx4 v[132:135], v1, s[8:11], s24 offen offset:1024 sc1
L_PF2:
    s_waitcnt vmcnt(0)
    v_bitop3_b32 v136, v128, v132, v7 bitop3:0x7e
    v_and_b32 v128, 0xffffff00, v128
    v_and_b32 v132, 0xffffff00, v132
    v_pk_add_f32 v[130:131], v[130:131], v[134:135]
    v_pk_add_f32 v[128:129], v[128:129], v[132:133]
    v_cmp_ne_u32_sdwa vcc, v136, 0 src0_sel:BYTE_0 src1_sel:DWORD
    v_permlane32_swap_b32 v130, v131
    s_cbranch_vccnz L_rt_134
    v_permlane32_swap_b32 v128, v129
    v_add_f32 v130, v130, v131
    v_add_f32 v128, v128, v129
    s_nop 1
    v_permlane16_swap_b32 v128, v130
    v_add_f32 v128, v128, v130
    s_nop 1
    v_add_f32_dpp v128, v128, v128 row_ror:8 row_mask:0xf bank_mask:0xf
    v_add_f32 v2, v128, v2
    v_cvt_pk_bf16_f32 v129, v2, v2
    buffer_store_short v129, v162, s[52:55], 0 offen
    s_branch L_fin_done
L_fin_ep:
    s_lshl_b32 s7, s59, 3
    s_add_u32 s7, s7, s6
    s_cmp_eq_u32 s7, 7
    s_cbranch_scc0 L_fin_done
    v_mov_b32 v148, s18
    s_mov_b64 exec, 1
    buffer_store_dword v148, v1, s[8:11], 0 offen sc1
    s_mov_b64 exec, -1
L_fin_done:
L_end:
    s_endpgm
L_rt_38:
    s_cmp_eq_u32 s42, 0
    s_cbranch_scc0 L_rs_39
    s_sleep 2
L_rs_39:
    s_sub_u32 s43, s43, 1
    s_cbranch_scc0 L_P1r_0
    s_endpgm
L_P1r_0:
    buffer_load_dwordx4 v[128:131], v1, s[8:11], s24 offen sc1
    buffer_load_dwordx4 v[132:135], v1, s[8:11], s24 offen offset:1024 sc1
    s_branch L_P1w_0
L_rt_40:
    s_sub_u32 s43, s43, 1
    s_cbranch_scc0 L_P2_0
    s_endpgm
L_rt_41:
    s_sub_u32 s43, s43, 1
    s_cbranch_scc0 L_P2_0
    s_endpgm
L_P3r_0:
    s_wqm_b64 exec, vcc
    buffer_load_dwordx4 v[120:123], v1, s[8:11], s62 offen sc1
    s_waitcnt vmcnt(1)
    v_cmp_ne_u32_sdwa vcc, v124, v7 src0_sel:BYTE_0 src1_sel:BYTE_0
    v_mov_b64 v[130:131], v[126:127]
    v_and_b32 v128, 0xffffff00, v124
    v_mov_b32 v129, v125
    s_cbranch_vccz L_P3d_0
    s_wqm_b64 exec, vcc
    buffer_load_dwordx4 v[124:127], v1, s[8:11], s62 offen sc1
    s_sub_u32 s43, s43, 1
    s_cbranch_scc0 L_P3l_0
    s_endpgm
L_rt_52:
    s_sub_u32 s43, s43, 1
    s_cbranch_scc0 L_P4_0
    s_endpgm
L_rt_53:
    ds_read_b64 v[150:151], v160 offset:0
    s_sub_u32 s43, s43, 1
    s_cbranch_scc0 L_P4a_0
    s_endpgm
L_rt_54:
    v_mov_b64 v[140:141], 0
    v_mov_b64 v[142:143], 0
    s_sub_u32 s43, s43, 1
    s_cbranch_scc0 L_P4_0
    s_endpgm
L_rt_60:
    ds_read_b128 v[128:131], v157 offset:0
    ds_read_b32 v132, v158 offset:0
    s_sub_u32 s43, s43, 1
    s_cbranch_scc0 L_P5_0
    s_endpgm
L_rt_63:
    v_mov_b64 v[112:113], 0
    v_mov_b64 v[118:119], 0
    ds_read_b128 v[128:131], v157 offset:0
    ds_read_b32 v132, v158 offset:0
    s_sub_u32 s43, s43, 1
    s_cbranch_scc0 L_P5_0
    s_endpgm
L_rt_64:
    s_mov_b64 exec, vcc
    buffer_load_dwordx4 v[104:107], v1, s[8:11], s21 offen offset:0 sc1
    s_mov_b64 exec, -1
    s_sub_u32 s43, s43, 1
    s_cbranch_scc0 L_P6l_0_2
    s_endpgm
L_P6w_0_2:
L_P6v_0_2:
    s_waitcnt lgkmcnt(0)
    v_cmp_u_f32 vcc, v144, v147
    s_cbranch_vccz L_P6y_0_2
    ds_read_b128 v[144:147], v160 offset:128
    s_sub_u32 s43, s43, 1
    s_cbranch_scc0 L_P6v_0_2
    s_endpgm
L_rt_65:
    s_sub_u32 s43, s43, 1
    s_cbranch_scc0 L_P6_0_2
    s_endpgm
L_rt_68:
    ds_read_b128 v[128:131], v140 offset:0
    s_sub_u32 s43, s43, 1
    s_cbranch_scc0 L_RD_0_2
    s_endpgm
L_rt_101:
    s_cmp_eq_u32 s42, 0
    s_cbranch_scc0 L_rs_102
    s_sleep 2
L_rs_102:
    s_sub_u32 s43, s43, 1
    s_cbranch_scc0 L_P1r_1
    s_endpgm
L_P1r_1:
    buffer_load_dwordx4 v[128:131], v1, s[8:11], s23 offen sc1
    buffer_load_dwordx4 v[132:135], v1, s[8:11], s23 offen offset:1024 sc1
    s_branch L_P1w_1
L_rt_103:
    s_sub_u32 s43, s43, 1
    s_cbranch_scc0 L_P2_1
    s_endpgm
L_rt_104:
    s_sub_u32 s43, s43, 1
    s_cbranch_scc0 L_P2_1
    s_endpgm
L_P3r_1:
    s_wqm_b64 exec, vcc
    buffer_load_dwordx4 v[120:123], v1, s[8:11], s62 offen sc1
    s_waitcnt vmcnt(1)
    v_cmp_ne_u32_sdwa vcc, v124, v7 src0_sel:BYTE_0 src1_sel:BYTE_0
    v_mov_b64 v[130:131], v[126:127]
    v_and_b32 v128, 0xffffff00, v124
    v_mov_b32 v129, v125
    s_cbranch_vccz L_P3d_1
    s_wqm_b64 exec, vcc
    buffer_load_dwordx4 v[124:127], v1, s[8:11], s62 offen sc1
    s_sub_u32 s43, s43, 1
    s_cbranch_scc0 L_P3l_1
    s_endpgm
L_rt_114:
    s_sub_u32 s43, s43, 1
    s_cbranch_scc0 L_P4_1
    s_endpgm
L_rt_115:
    ds_read_b64 v[150:151], v160 offset:5760
    s_sub_u32 s43, s43, 1
    s_cbranch_scc0 L_P4a_1
    s_endpgm
L_rt_116:
    v_mov_b64 v[140:141], 0
    v_mov_b64 v[142:143], 0
    s_sub_u32 s43, s43, 1
    s_cbranch_scc0 L_P4_1
    s_endpgm
L_rt_119:
    ds_read_b128 v[128:131], v157 offset:5760
    ds_read_b32 v132, v158 offset:5760
    s_sub_u32 s43, s43, 1
    s_cbranch_scc0 L_P5_1
    s_endpgm
L_rt_122:
    v_mov_b64 v[112:113], 0
    v_mov_b64 v[118:119], 0
    ds_read_b128 v[128:131], v157 offset:5760
    ds_read_b32 v132, v158 offset:5760
    s_sub_u32 s43, s43, 1
    s_cbranch_scc0 L_P5_1
    s_endpgm
L_rt_123:
    s_mov_b64 exec, vcc
    buffer_load_dwordx4 v[104:107], v1, s[8:11], s22 offen offset:0 sc1
    s_mov_b64 exec, -1
    s_sub_u32 s43, s43, 1
    s_cbranch_scc0 L_P6l_1_2
    s_endpgm
L_pad6:
    s_branch L_padret
L_P6w_1_2:
L_P6v_1_2:
    s_waitcnt lgkmcnt(0)
    v_cmp_u_f32 vcc, v144, v147
    s_cbranch_vccz L_P6y_1_2
    ds_read_b128 v[144:147], v160 offset:5888
    s_sub_u32 s43, s43, 1
    s_cbranch_scc0 L_P6v_1_2
    s_endpgm
L_rt_124:
    s_sub_u32 s43, s43, 1
    s_cbranch_scc0 L_P6_1_2
    s_endpgm
L_rt_127:
    ds_read_b128 v[128:131], v140 offset:5760
    s_sub_u32 s43, s43, 1
    s_cbranch_scc0 L_RD_1_2
    s_endpgm
L_rt_133:
    s_sub_u32 s43, s43, 1
    s_cbranch_scc0 L_PF2
    s_endpgm
L_rt_134:
    s_sub_u32 s43, s43, 1
    s_cbranch_scc0 L_PF
    s_endpgm
L_ePG3:
    .p2align 12
L_PG3:
L_pad7:
    s_branch L_padret
L_rt_49:
    s_sleep 1
    s_sub_u32 s43, s43, 1
    s_cbranch_scc0 L_wp_48
    s_endpgm
L_rt_50:
    s_sleep 2
    buffer_load_dwordx4 v[124:127], v1, s[8:11], s63 offen sc1
    buffer_load_dwordx4 v[120:123], v1, s[8:11], s62 offen sc1
    s_sub_u32 s43, s43, 1
    s_cbranch_scc0 L_P3c_0
    s_endpgm
L_rt_51:
    s_sleep 2
    buffer_load_dwordx4 v[120:123], v1, s[8:11], s62 offen sc1
    s_sub_u32 s43, s43, 1
    s_cbranch_scc0 L_P3y
    s_endpgm
L_P3z_0:
    s_waitcnt vmcnt(0)
    buffer_load_dwordx4 v[124:127], v1, s[8:11], s63 offen sc1
    buffer_load_dwordx4 v[120:123], v1, s[8:11], s62 offen sc1
    s_lshl_b32 s14, s6, 2
    s_add_u32 s14, s14, 22
    v_and_b32 v144, 15, v0
    v_lshrrev_b32 v145, 4, v0
    v_xor_b32 v145, v145, v144
    v_lshlrev_b32 v144, 8, v144
    v_lshl_add_u32 v144, v145, 4, v144
    s_lshl_b32 s7, s6, 12
    s_add_u32 s7, s7, 36864
    v_add_u32 v144, s7, v144
    v_xor_b32 v145, 64, v144
    v_xor_b32 v146, 128, v144
    v_xor_b32 v147, 192, v144
    v_mov_b32 v148, 158208
L_wp_48:
    ds_read_b32 v149, v148
    s_waitcnt lgkmcnt(0)
    v_cmp_gt_i32 vcc, s14, v149
    s_cbranch_vccnz L_rt_49
    ds_read_b128 v[8:11], v144
    ds_read_b128 v[12:15], v145
    ds_read_b128 v[16:19], v146
    ds_read_b128 v[20:23], v147
    s_waitcnt lgkmcnt(0)
    s_lshl_b32 s7, s6, 2
    s_add_u32 s7, s7, 158272
    v_mov_b32 v148, s7
    v_mov_b32 v149, 1
    ds_write_b32 v148, v149
L_P3c_0:
    s_waitcnt vmcnt(1)
    v_cmp_ne_u32_sdwa vcc, v124, v7 src0_sel:BYTE_0 src1_sel:BYTE_0
    v_and_b32 v124, 0xffffff00, v124
    v_permlane32_swap_b32 v126, v127
    s_cbranch_vccnz L_rt_50
    v_permlane32_swap_b32 v124, v125
    v_add_f32 v126, v126, v127
    v_add_f32 v124, v124, v125
    s_nop 1
    v_permlane16_swap_b32 v124, v126
    v_add_f32 v124, v124, v126
    s_nop 1
    v_add_f32_dpp v124, v124, v124 row_ror:8 row_mask:0xf bank_mask:0xf
    v_cvt_pk_bf16_f32 v148, v124, v124
    ds_write_b16 v153, v148 offset:640
    ds_write_b16 v153, v148 offset:12160
L_P3y:
    s_waitcnt vmcnt(0)
    v_cmp_ne_u32_sdwa vcc, v120, v7 src0_sel:BYTE_0 src1_sel:BYTE_0
    v_mov_b64 v[130:131], v[122:123]
    v_and_b32 v128, 0xffffff00, v120
    v_mov_b32 v129, v121
    s_cbranch_vccnz L_rt_51
    v_permlane32_swap_b32 v130, v131
    v_permlane32_swap_b32 v128, v129
    v_add_f32 v130, v130, v131
    v_add_f32 v128, v128, v129
    s_nop 1
    v_permlane16_swap_b32 v128, v130
    v_add_f32 v128, v128, v130
    s_nop 1
    v_add_f32_dpp v128, v128, v128 row_ror:8 row_mask:0xf bank_mask:0xf
    v_cvt_pk_bf16_f32 v129, v128, v128
    ds_write_b16 v153, v129 offset:0
    s_branch L_P4_0
L_rt_58:
    s_sleep 1
    s_sub_u32 s43, s43, 1
    s_cbranch_scc0 L_wp_57
    s_endpgm
L_rt_59:
    s_sleep 2
    s_sub_u32 s43, s43, 1
    s_cbranch_scc0 L_gow
    s_endpgm
L_P5z:
    v_bfe_u32 v144, v0, 3, 1
    v_mul_u32_u24 v144, 66, v144
    v_bfe_u32 v145, v0, 4, 1
    v_mad_u32_u24 v144, v145, 24, v144
    v_lshrrev_b32 v145, 5, v0
    v_lshl_add_u32 v144, v145, 2, v144
    v_bfe_u32 v145, v0, 2, 1
    v_add_lshl_u32 v144, v144, v145, 8
    v_bfe_u32 v145, v0, 2, 3
    v_xor_b32 v145, s6, v145
    v_lshl_add_u32 v144, v145, 5, v144
    v_and_b32 v145, 3, v0
    v_lshl_add_u32 v144, v145, 3, v144
    v_add_u32 v144, 69632, v144
    v_xor_b32 v145, 576, v144
    v_xor_b32 v146, 2176, v144
    v_xor_b32 v147, 2752, v144
    s_movk_i32 s14, 82
    v_mov_b32 v148, 158208
L_wp_57:
    ds_read_b32 v149, v148
    s_waitcnt lgkmcnt(0)
    v_cmp_gt_i32 vcc, s14, v149
    s_cbranch_vccnz L_rt_58
    ds_read_b64_tr_b16 v[24:25], v144 offset:0
    ds_read_b64_tr_b16 v[26:27], v145 offset:0
    ds_read_b64_tr_b16 v[28:29], v146 offset:0
    ds_read_b64_tr_b16 v[30:31], v147 offset:0
    ds_read_b64_tr_b16 v[32:33], v144 offset:8192
    ds_read_b64_tr_b16 v[34:35], v145 offset:8192
    ds_read_b64_tr_b16 v[36:37], v146 offset:8192
    ds_read_b64_tr_b16 v[38:39], v147 offset:8192
    s_waitcnt lgkmcnt(0)
    s_lshl_b32 s7, s6, 2
    s_add_u32 s7, s7, 158272
    v_mov_b32 v148, s7
    v_mov_b32 v149, 2
    ds_write_b32 v148, v149
    v_mov_b32 v148, 158336
L_gow:
    ds_read_b32 v149, v148
    s_waitcnt lgkmcnt(0)
    v_readfirstlane_b32 s58, v149
    s_cmp_lt_i32 s58, 0
    s_cbranch_scc1 L_rt_59
    s_branch L_P5y
L_rt_74:
    s_sleep 1
    s_sub_u32 s43, s43, 1
    s_cbranch_scc0 L_wp_73
    s_endpgm
L_P6z_0_2:
    s_mov_b32 s51, s58
    s_add_u32 s50, s61, 2048
    s_cmp_lt_u32 s6, s51
    s_cbranch_scc0 L_hn_70
    v_lshlrev_b32 v150, 7, v0
    v_mov_b32 v151, s18
    s_add_u32 s7, s50, s5
    s_mov_b64 exec, 0xffff
    buffer_store_byte v151, v150, s[8:11], s7 offen
    s_mov_b64 exec, -1
L_hn_70:
    s_cmp_eq_u32 s51, 0
    s_cbranch_scc1 L_hs_69
    s_and_b32 s48, s18, 0xff
    s_mul_i32 s48, s48, 0x01010101
    s_mov_b32 s49, s48
    s_mov_b32 s51, 15
L_hl_71:
    s_load_dwordx4 s[44:47], s[40:41], s50
    s_add_u32 s50, s50, 128
    s_waitcnt lgkmcnt(0)
    s_xor_b64 s[44:45], s[44:45], s[48:49]
    s_xor_b64 s[46:47], s[46:47], s[48:49]
    s_or_b64 s[44:45], s[44:45], s[46:47]
    s_cbranch_scc0 L_hk_72
    s_sleep 1
    s_sub_u32 s51, s51, 1
    s_cbranch_scc0 L_hl_71
L_hs_69:
    s_waitcnt vmcnt(0) lgkmcnt(0)
L_hk_72:
    v_mov_b32 v148, 158336
    ds_write_b32 v148, v148 offset:4
    buffer_load_dwordx4 v[104:107], v1, s[8:11], s21 offen offset:0 sc1
    s_lshl_b32 s7, s6, 2
    s_add_u32 s7, s7, 158272
    v_mov_b32 v148, s7
    v_mov_b32 v149, 3
    ds_write_b32 v148, v149
    s_or_b32 s14, s6, s15
    s_add_u32 s14, s14, 1
    s_lshl_b32 s14, s14, 1
    s_add_u32 s14, s14, 82
    v_lshrrev_b32 v144, 4, v0
    v_bfe_u32 v145, v0, 2, 2
    v_lshl_add_u32 v145, v144, 3, v145
    v_and_b32 v144, 1, v144
    s_lshl_b32 s7, s6, 11
    s_add_u32 s7, s7, 102400
    v_and_b32 v146, 3, v0
    v_lshl_add_u32 v146, v146, 3, s7
    v_lshl_add_u32 v146, v144, 5, v146
    v_lshl_add_u32 v146, v145, 6, v146
    v_xor_b32 v147, 32, v146
    v_mov_b32 v148, 158208
L_wp_73:
    ds_read_b32 v149, v148
    s_waitcnt lgkmcnt(0)
    v_cmp_gt_i32 vcc, s14, v149
    s_cbranch_vccnz L_rt_74
    ds_read_b64_tr_b16 v[72:73], v146 offset:0
    ds_read_b64_tr_b16 v[74:75], v146 offset:256
    ds_read_b64_tr_b16 v[76:77], v147 offset:0
    ds_read_b64_tr_b16 v[78:79], v147 offset:256
    s_waitcnt lgkmcnt(0)
    s_lshl_b32 s7, s6, 2
    s_add_u32 s7, s7, 158272
    v_mov_b32 v148, s7
    v_mov_b32 v149, 4
    ds_write_b32 v148, v149
L_P6x_0_2:
    ds_read_b128 v[144:147], v160 offset:128
    s_waitcnt vmcnt(0)
    v_cmp_u_f32 vcc, v104, v107
    s_cbranch_vccz L_P6d_0_2
    buffer_load_dwordx4 v[104:107], v1, s[8:11], s21 offen offset:0 sc1
    s_sub_u32 s43, s43, 1
    s_cbranch_scc0 L_P6x_0_2
    s_endpgm
L_rt_75:
    s_mov_b64 exec, vcc
    buffer_load_dwordx4 v[104:107], v1, s[8:11], s21 offen offset:0 sc1
    buffer_load_dwordx4 v[108:111], v1, s[8:11], s21 offen offset:1024 sc1
    s_mov_b64 exec, -1
    s_sub_u32 s43, s43, 1
    s_cbranch_scc0 L_P6l_0_4
    s_endpgm
L_P6w_0_4:
L_P6v_0_4:
    s_waitcnt lgkmcnt(0)
    v_cmp_u_f32 vcc, v144, v147
    s_cbranch_vccz L_P6y_0_4
    ds_read_b128 v[144:147], v160 offset:128
    s_sub_u32 s43, s43, 1
    s_cbranch_scc0 L_P6v_0_4
    s_endpgm
L_rt_76:
    s_sub_u32 s43, s43, 1
    s_cbranch_scc0 L_P6_0_4
    s_endpgm
L_rt_79:
    ds_read_b128 v[128:131], v140 offset:0
    s_sub_u32 s43, s43, 1
    s_cbranch_scc0 L_RD_0_4
    s_endpgm
L_P6s_0_4:
    s_cmp_eq_u32 s42, 0
    s_cbranch_scc1 L_P6z_0_4
    s_sleep 2
L_P6_0_4:
    buffer_load_dwordx4 v[104:107], v1, s[8:11], s21 offen offset:0 sc1
    buffer_load_dwordx4 v[108:111], v1, s[8:11], s21 offen offset:1024 sc1
    s_sleep 2
L_P6j_0_4:
    buffer_load_dwordx4 v[104:107], v1, s[8:11], s21 offen offset:0 sc1
    buffer_load_dwordx4 v[108:111], v1, s[8:11], s21 offen offset:1024 sc1
L_P6l_0_4:
    ds_read_b128 v[144:147], v160 offset:128
    s_waitcnt vmcnt(2)
    v_cmp_u_f32 vcc, v104, v108
    s_cbranch_vccnz L_rt_75
L_P6d_0_4:
    ds_read_b128 v[144:147], v160 offset:128
    v_mfma_f32_16x16x32_bf16 v[112:115], v[104:107], v[72:75], 0
    v_mfma_f32_16x16x32_bf16 v[116:119], v[104:107], v[76:79], 0
    v_mfma_f32_16x16x32_bf16 v[112:115], v[108:111], v[80:83], v[112:115]
    v_mfma_f32_16x16x32_bf16 v[116:119], v[108:111], v[84:87], v[116:119]
    s_waitcnt lgkmcnt(1)
    v_cmp_u_f32 vcc, v144, v147
    s_cbranch_vccnz L_P6w_0_4
L_P6y_0_4:
    s_nop 3
    v_pk_mul_f32 v[112:113], v[112:113], v[144:145]
    v_pk_mul_f32 v[116:117], v[116:117], v[144:145]
    v_pk_fma_f32 v[112:113], v[114:115], v[146:147], v[112:113]
    v_pk_fma_f32 v[116:117], v[118:119], v[146:147], v[116:117]
    v_add_f32 v148, v112, v113
    v_add_f32 v149, v116, v117
    v_cmp_u_f32 vcc, v148, v149
    s_cmp_eq_u32 s42, 0
    v_permlane16_swap_b32 v148, v149
    v_add_f32 v148, v148, v149
    ds_write_b32 v163, v148 offset:0
    s_cbranch_vccnz L_rt_76
    s_cbranch_scc1 L_P6b_0_4
    s_barrier
L_P6b_0_4:
    ds_read_b128 v[128:131], v140 offset:0
    s_cmp_eq_u32 s58, 0
    s_cbranch_scc1 L_sl_77
    buffer_store_short v141, v159, s[8:11], s20 offen
L_sd_78:
    s_add_u32 s7, s25, 73856
L_RD_0_4:
    s_waitcnt lgkmcnt(0)
    v_pk_add_f32 v[128:129], v[128:129], v[130:131]
    v_add_f32 v128, v128, v129
    v_cmp_u_f32 vcc, v128, v128
    v_mov_b32_sdwa v128, v7 dst_sel:BYTE_0 dst_unused:UNUSED_PRESERVE src0_sel:BYTE_2
    s_cbranch_vccnz L_rt_79
    buffer_store_dword v128, v161, s[8:11], s25 offen sc1
    buffer_store_dword v128, v161, s[8:11], s7 offen sc1
    s_branch L_P6f_0
L_rt_85:
    s_sleep 1
    s_sub_u32 s43, s43, 1
    s_cbranch_scc0 L_wp_84
    s_endpgm
L_P6z_0_4:
    s_mov_b32 s51, s58
    s_add_u32 s50, s61, 2048
    s_cmp_lt_u32 s6, s51
    s_cbranch_scc0 L_hn_81
    v_lshlrev_b32 v150, 7, v0
    v_mov_b32 v151, s18
    s_add_u32 s7, s50, s5
    s_mov_b64 exec, 0xffff
    buffer_store_byte v151, v150, s[8:11], s7 offen
    s_mov_b64 exec, -1
L_hn_81:
    s_cmp_eq_u32 s51, 0
    s_cbranch_scc1 L_hs_80
    s_and_b32 s48, s18, 0xff
    s_mul_i32 s48, s48, 0x01010101
    s_mov_b32 s49, s48
    s_mov_b32 s51, 15
L_hl_82:
    s_load_dwordx4 s[44:47], s[40:41], s50
    s_add_u32 s50, s50, 128
    s_waitcnt lgkmcnt(0)
    s_xor_b64 s[44:45], s[44:45], s[48:49]
    s_xor_b64 s[46:47], s[46:47], s[48:49]
    s_or_b64 s[44:45], s[44:45], s[46:47]
    s_cbranch_scc0 L_hk_83
    s_sleep 1
    s_sub_u32 s51, s51, 1
    s_cbranch_scc0 L_hl_82
L_hs_80:
    s_waitcnt vmcnt(0) lgkmcnt(0)
L_hk_83:
    v_mov_b32 v148, 158336
    ds_write_b32 v148, v148 offset:4
    buffer_load_dwordx4 v[104:107], v1, s[8:11], s21 offen offset:0 sc1
    buffer_load_dwordx4 v[108:111], v1, s[8:11], s21 offen offset:1024 sc1
    s_lshl_b32 s7, s6, 2
    s_add_u32 s7, s7, 158272
    v_mov_b32 v148, s7
    v_mov_b32 v149, 3
    ds_write_b32 v148, v149
    s_or_b32 s14, s6, s15
    s_add_u32 s14, s14, 1
    s_lshl_b32 s14, s14, 2
    s_add_u32 s14, s14, 82
    v_lshrrev_b32 v144, 4, v0
    v_bfe_u32 v145, v0, 2, 2
    v_lshl_add_u32 v145, v144, 3, v145
    v_and_b32 v144, 1, v144
    s_lshr_b32 s7, s6, 1
    s_lshl_b32 s7, s7, 13
    s_add_u32 s7, s7, 102400
    v_and_b32 v146, 3, v0
    v_lshl_add_u32 v146, v146, 3, s7
    v_bfe_u32 v147, v0, 3, 1
    v_lshl_or_b32 v144, v144, 1, v147
    s_and_b32 s7, s6, 1
    s_lshl_b32 s7, s7, 1
    v_xor_b32 v144, s7, v144
    v_lshl_add_u32 v146, v144, 5, v146
    v_lshl_add_u32 v146, v145, 7, v146
    v_xor_b32 v147, 32, v146
    v_mov_b32 v148, 158208
L_wp_84:
    ds_read_b32 v149, v148
    s_waitcnt lgkmcnt(0)
    v_cmp_gt_i32 vcc, s14, v149
    s_cbranch_vccnz L_rt_85
    ds_read_b64_tr_b16 v[72:73], v146 offset:0
    ds_read_b64_tr_b16 v[74:75], v146 offset:512
    ds_read_b64_tr_b16 v[76:77], v147 offset:0
    ds_read_b64_tr_b16 v[78:79], v147 offset:512
    ds_read_b64_tr_b16 v[80:81], v146 offset:4096
    ds_read_b64_tr_b16 v[82:83], v146 offset:4608
    ds_read_b64_tr_b16 v[84:85], v147 offset:4096
    ds_read_b64_tr_b16 v[86:87], v147 offset:4608
    s_waitcnt lgkmcnt(0)
    s_lshl_b32 s7, s6, 2
    s_add_u32 s7, s7, 158272
    v_mov_b32 v148, s7
    v_mov_b32 v149, 4
    ds_write_b32 v148, v149
L_P6x_0_4:
    ds_read_b128 v[144:147], v160 offset:128
    s_waitcnt vmcnt(0)
    v_cmp_u_f32 vcc, v104, v108
    s_cbranch_vccz L_P6d_0_4
    buffer_load_dwordx4 v[104:107], v1, s[8:11], s21 offen offset:0 sc1
    buffer_load_dwordx4 v[108:111], v1, s[8:11], s21 offen offset:1024 sc1
    s_sub_u32 s43, s43, 1
    s_cbranch_scc0 L_P6x_0_4
    s_endpgm
L_rt_89:
    s_sleep 1
    s_sub_u32 s43, s43, 1
    s_cbranch_scc0 L_wp_88
    s_endpgm
L_rt_93:
    s_sleep 1
    s_sub_u32 s43, s43, 1
    s_cbranch_scc0 L_wp_92
    s_endpgm
L_rt_95:
    s_sleep 1
    s_sub_u32 s43, s43, 1
    s_cbranch_scc0 L_wp_94
    s_endpgm
L_rt_99:
    s_sleep 1
    s_sub_u32 s43, s43, 1
    s_cbranch_scc0 L_wp_98
    s_endpgm
L_sg_86:
    s_lshl_b32 s7, s6, 2
    s_add_u32 s7, s7, 158272
    v_mov_b32 v148, s7
    v_mov_b32 v149, 5
    ds_write_b32 v148, v149
    s_movk_i32 s14, 100
    s_add_u32 s14, s14, s57
    v_mov_b32 v148, 158208
L_wp_88:
    ds_read_b32 v149, v148
    s_waitcnt lgkmcnt(0)
    v_cmp_gt_i32 vcc, s14, v149
    s_cbranch_vccnz L_rt_89
    ds_read_b64_tr_b16 v[48:49], v5 offset:28672
    ds_read_b64_tr_b16 v[50:51], v5 offset:29696
    ds_read_b64_tr_b16 v[40:41], v5 offset:18432
    ds_read_b64_tr_b16 v[42:43], v5 offset:19456
    ds_read_b64_tr_b16 v[44:45], v5 offset:26624
    ds_read_b64_tr_b16 v[46:47], v5 offset:27648
    ds_read_b128 v[60:63], v152 offset:5760
    ds_read_b128 v[56:59], v4 offset:5760
    s_add_u32 s7, s18, 0x07050301
    s_and_b32 s7, s7, 0x7f7f7f7f
    v_perm_b32 v148, s7, s7, v164
    s_waitcnt lgkmcnt(0)
    v_mfma_f32_16x16x32_bf16 v[64:67], v[60:63], v[48:51], 0
    v_smfmac_f32_16x16x64_bf16 v[64:67], v[56:59], v[40:47], v165
    s_cmp_eq_u32 s58, 0
    s_nop 6
    v_add_f32 v64, v64, v66
    v_mov_b32_sdwa v64, v148 dst_sel:BYTE_0 dst_unused:UNUSED_PRESERVE src0_sel:BYTE_2
    s_mov_b32 exec_lo, 0
    s_cbranch_scc1 L_sl_90
    buffer_store_dword v64, v6, s[8:11], s60 offen
L_sd_91:
    v_mov_b32 v6, 2147418112
    s_mov_b32 exec_lo, -1
    s_lshl_b32 s14, s6, 2
    s_add_u32 s14, s14, 104
    s_add_u32 s14, s14, s57
    v_and_b32 v144, 15, v0
    v_lshrrev_b32 v145, 4, v0
    v_xor_b32 v145, v145, v144
    v_lshlrev_b32 v144, 8, v144
    v_lshl_add_u32 v144, v145, 4, v144
    s_lshl_b32 s7, s6, 12
    s_add_u32 s7, s7, 36864
    v_add_u32 v144, s7, v144
    v_xor_b32 v145, 64, v144
    v_xor_b32 v146, 128, v144
    v_xor_b32 v147, 192, v144
    v_mov_b32 v148, 158208
L_wp_92:
    ds_read_b32 v149, v148
    s_waitcnt lgkmcnt(0)
    v_cmp_gt_i32 vcc, s14, v149
    s_cbranch_vccnz L_rt_93
    ds_read_b128 v[40:43], v144
    ds_read_b128 v[44:47], v145
    ds_read_b128 v[48:51], v146
    ds_read_b128 v[52:55], v147
    v_bfe_u32 v144, v0, 3, 1
    v_mul_u32_u24 v144, 66, v144
    v_bfe_u32 v145, v0, 4, 1
    v_mad_u32_u24 v144, v145, 24, v144
    v_lshrrev_b32 v145, 5, v0
    v_lshl_add_u32 v144, v145, 2, v144
    v_bfe_u32 v145, v0, 2, 1
    v_add_lshl_u32 v144, v144, v145, 8
    v_bfe_u32 v145, v0, 2, 3
    v_xor_b32 v145, s6, v145
    v_lshl_add_u32 v144, v145, 5, v144
    v_and_b32 v145, 3, v0
    v_lshl_add_u32 v144, v145, 3, v144
    v_add_u32 v144, 69632, v144
    v_xor_b32 v145, 576, v144
    v_xor_b32 v146, 2176, v144
    v_xor_b32 v147, 2752, v144
    s_movk_i32 s14, 164
    s_add_u32 s14, s14, s57
    v_mov_b32 v148, 158208
L_wp_94:
    ds_read_b32 v149, v148
    s_waitcnt lgkmcnt(0)
    v_cmp_gt_i32 vcc, s14, v149
    s_cbranch_vccnz L_rt_95
    ds_read_b64_tr_b16 v[56:57], v144 offset:0
    ds_read_b64_tr_b16 v[58:59], v145 offset:0
    ds_read_b64_tr_b16 v[60:61], v146 offset:0
    ds_read_b64_tr_b16 v[62:63], v147 offset:0
    ds_read_b64_tr_b16 v[64:65], v144 offset:8192
    ds_read_b64_tr_b16 v[66:67], v145 offset:8192
    ds_read_b64_tr_b16 v[68:69], v146 offset:8192
    ds_read_b64_tr_b16 v[70:71], v147 offset:8192
    s_cmp_eq_u32 s57, 32
    s_cbranch_scc1 L_n4_96
    v_lshrrev_b32 v144, 4, v0
    v_bfe_u32 v145, v0, 2, 2
    v_lshl_add_u32 v145, v144, 3, v145
    v_and_b32 v144, 1, v144
    s_lshl_b32 s7, s6, 11
    s_add_u32 s7, s7, 102400
    v_and_b32 v146, 3, v0
    v_lshl_add_u32 v146, v146, 3, s7
    v_lshl_add_u32 v146, v144, 5, v146
    v_lshl_add_u32 v146, v145, 6, v146
    v_xor_b32 v147, 32, v146
    s_branch L_nd_97
L_n4_96:
    v_lshrrev_b32 v144, 4, v0
    v_bfe_u32 v145, v0, 2, 2
    v_lshl_add_u32 v145, v144, 3, v145
    v_and_b32 v144, 1, v144
    s_lshr_b32 s7, s6, 1
    s_lshl_b32 s7, s7, 13
    s_add_u32 s7, s7, 102400
    v_and_b32 v146, 3, v0
    v_lshl_add_u32 v146, v146, 3, s7
    v_bfe_u32 v147, v0, 3, 1
    v_lshl_or_b32 v144, v144, 1, v147
    s_and_b32 s7, s6, 1
    s_lshl_b32 s7, s7, 1
    v_xor_b32 v144, s7, v144
    v_lshl_add_u32 v146, v144, 5, v146
    v_lshl_add_u32 v146, v145, 7, v146
    v_xor_b32 v147, 32, v146
L_nd_97:
    s_mul_i32 s14, s56, -4
    s_add_u32 s14, s14, 150
    s_add_u32 s14, s14, s57
    s_add_u32 s14, s14, s57
    v_mov_b32 v148, 158208
L_wp_98:
    ds_read_b32 v149, v148
    s_waitcnt lgkmcnt(0)
    v_cmp_gt_i32 vcc, s14, v149
    s_cbranch_vccnz L_rt_99
    s_branch L_sg_87
L_rt_110:
    s_sleep 1
    s_sub_u32 s43, s43, 1
    s_cbranch_scc0 L_wp_109
    s_endpgm
L_rt_112:
    s_sleep 1
    s_sub_u32 s43, s43, 1
    s_cbranch_scc0 L_wp_111
    s_endpgm
L_rt_113:
    buffer_load_dwordx4 v[132:135], v1, s[8:11], s63 offen sc1
    s_waitcnt vmcnt(0)
    s_sub_u32 s43, s43, 1
    s_cbranch_scc0 L_P3c_1
    s_endpgm
L_P3z_1:
    buffer_load_dwordx4 v[132:135], v1, s[8:11], s63 offen sc1
    s_cmp_eq_u32 s57, 32
    s_cbranch_scc1 L_n4_107
    s_or_b32 s14, s6, s15
    s_add_u32 s14, s14, 1
    s_lshl_b32 s14, s14, 1
    s_add_u32 s14, s14, 164
    s_add_u32 s14, s14, s57
    v_mov_b32 v148, 158208
L_wp_109:
    ds_read_b32 v149, v148
    s_waitcnt lgkmcnt(0)
    v_cmp_gt_i32 vcc, s14, v149
    s_cbranch_vccnz L_rt_110
    ds_read_b64_tr_b16 v[88:89], v146 offset:0
    ds_read_b64_tr_b16 v[90:91], v146 offset:256
    ds_read_b64_tr_b16 v[92:93], v147 offset:0
    ds_read_b64_tr_b16 v[94:95], v147 offset:256
    s_branch L_nd_108
L_n4_107:
    s_or_b32 s14, s6, s15
    s_add_u32 s14, s14, 1
    s_lshl_b32 s14, s14, 2
    s_add_u32 s14, s14, 164
    s_add_u32 s14, s14, s57
    v_mov_b32 v148, 158208
L_wp_111:
    ds_read_b32 v149, v148
    s_waitcnt lgkmcnt(0)
    v_cmp_gt_i32 vcc, s14, v149
    s_cbranch_vccnz L_rt_112
    ds_read_b64_tr_b16 v[88:89], v146 offset:0
    ds_read_b64_tr_b16 v[90:91], v146 offset:512
    ds_read_b64_tr_b16 v[92:93], v147 offset:0
    ds_read_b64_tr_b16 v[94:95], v147 offset:512
    ds_read_b64_tr_b16 v[96:97], v146 offset:4096
    ds_read_b64_tr_b16 v[98:99], v146 offset:4608
    ds_read_b64_tr_b16 v[100:101], v147 offset:4096
    ds_read_b64_tr_b16 v[102:103], v147 offset:4608
L_nd_108:
    s_waitcnt vmcnt(1)
    buffer_load_dwordx4 v[120:123], v1, s[8:11], s62 offen sc1
    s_sleep 1
    buffer_load_dwordx4 v[124:127], v1, s[8:11], s62 offen sc1
    s_waitcnt vmcnt(2)
L_P3c_1:
    v_cmp_ne_u32_sdwa vcc, v132, v7 src0_sel:BYTE_0 src1_sel:BYTE_0
    v_and_b32 v132, 0xffffff00, v132
    v_permlane32_swap_b32 v134, v135
    s_cbranch_vccnz L_rt_113
    v_permlane32_swap_b32 v132, v133
    v_add_f32 v134, v134, v135
    v_add_f32 v132, v132, v133
    s_nop 1
    v_permlane16_swap_b32 v132, v134
    v_add_f32 v132, v132, v134
    s_nop 1
    v_add_f32_dpp v132, v132, v132 row_ror:8 row_mask:0xf bank_mask:0xf
    v_cvt_pk_bf16_f32 v148, v132, v132
    ds_write_b16 v153, v148 offset:6400
    ds_write_b16 v153, v148 offset:17920
    s_branch L_P3l_1
L_rt_128:
    s_mov_b64 exec, vcc
    buffer_load_dwordx4 v[104:107], v1, s[8:11], s22 offen offset:0 sc1
    buffer_load_dwordx4 v[108:111], v1, s[8:11], s22 offen offset:1024 sc1
    s_mov_b64 exec, -1
    s_sub_u32 s43, s43, 1
    s_cbranch_scc0 L_P6l_1_4
    s_endpgm
L_P6w_1_4:
L_P6v_1_4:
    s_waitcnt lgkmcnt(0)
    v_cmp_u_f32 vcc, v144, v147
    s_cbranch_vccz L_P6y_1_4
    ds_read_b128 v[144:147], v160 offset:5888
    s_sub_u32 s43, s43, 1
    s_cbranch_scc0 L_P6v_1_4
    s_endpgm
L_rt_129:
    s_sub_u32 s43, s43, 1
    s_cbranch_scc0 L_P6_1_4
    s_endpgm
L_rt_132:
    ds_read_b128 v[128:131], v140 offset:5760
    s_sub_u32 s43, s43, 1
    s_cbranch_scc0 L_RD_1_4
    s_endpgm
L_P6s_1_4:
    s_sleep 2
L_P6_1_4:
    buffer_load_dwordx4 v[104:107], v1, s[8:11], s22 offen offset:0 sc1
    buffer_load_dwordx4 v[108:111], v1, s[8:11], s22 offen offset:1024 sc1
    s_sleep 2
L_P6j_1_4:
    buffer_load_dwordx4 v[104:107], v1, s[8:11], s22 offen offset:0 sc1
    buffer_load_dwordx4 v[108:111], v1, s[8:11], s22 offen offset:1024 sc1
L_P6l_1_4:
    ds_read_b128 v[144:147], v160 offset:5888
    s_waitcnt vmcnt(2)
    v_cmp_u_f32 vcc, v104, v108
    s_cbranch_vccnz L_rt_128
L_P6d_1_4:
    ds_read_b128 v[144:147], v160 offset:5888
    v_mfma_f32_16x16x32_bf16 v[112:115], v[104:107], v[88:91], 0
    v_mfma_f32_16x16x32_bf16 v[116:119], v[104:107], v[92:95], 0
    v_mfma_f32_16x16x32_bf16 v[112:115], v[108:111], v[96:99], v[112:115]
    v_mfma_f32_16x16x32_bf16 v[116:119], v[108:111], v[100:103], v[116:119]
    s_waitcnt lgkmcnt(1)
    v_cmp_u_f32 vcc, v144, v147
    s_cbranch_vccnz L_P6w_1_4
L_P6y_1_4:
    s_nop 3
    v_pk_mul_f32 v[112:113], v[112:113], v[144:145]
    v_pk_mul_f32 v[116:117], v[116:117], v[144:145]
    v_pk_fma_f32 v[112:113], v[114:115], v[146:147], v[112:113]
    v_pk_fma_f32 v[116:117], v[118:119], v[146:147], v[116:117]
    v_add_f32 v148, v112, v113
    v_add_f32 v149, v116, v117
    v_cmp_u_f32 vcc, v148, v149
    s_nop 0
    v_permlane16_swap_b32 v148, v149
    v_add_f32 v148, v148, v149
    ds_write_b32 v163, v148 offset:5760
    s_cbranch_vccnz L_rt_129
    s_barrier
L_P6b_1_4:
    ds_read_b128 v[128:131], v140 offset:5760
    s_mul_i32 s7, s42, s6
    s_cmp_gt_u32 s7, 1
    s_cbranch_scc1 L_P6f_1
    s_cmp_eq_u32 s58, 0
    s_cbranch_scc1 L_sl_130
    buffer_store_short v141, v159, s[8:11], s60 offen
L_sd_131:
    s_add_u32 s7, s26, 73856
L_RD_1_4:
    s_waitcnt lgkmcnt(0)
    v_pk_add_f32 v[128:129], v[128:129], v[130:131]
    v_add_f32 v128, v128, v129
    v_cmp_u_f32 vcc, v128, v128
    v_mov_b32_sdwa v128, v7 dst_sel:BYTE_0 dst_unused:UNUSED_PRESERVE src0_sel:BYTE_2
    s_cbranch_vccnz L_rt_132
    buffer_store_dword v128, v161, s[8:11], s26 offen sc1
    buffer_store_dword v128, v161, s[8:11], s7 offen sc1
    s_branch L_P6f_1
L_PGe:
L_sl_31:
    s_nop 7
    buffer_store_dwordx3 v[32:34], v1, s[8:11], s56 offen sc1
    s_branch L_sd_32
L_sl_42:
    s_nop 7
    buffer_store_dword v136, v6, s[8:11], s60 offen sc1
    s_branch L_sd_43
L_sl_55:
    s_nop 7
    buffer_store_dwordx2 v[138:139], v1, s[8:11], s27 offen offset:0 sc1
    s_branch L_sd_56
L_sl_61:
    s_nop 7
    buffer_store_short v136, v159, s[8:11], s60 offen sc1
    s_branch L_sd_62
L_sl_66:
    s_nop 7
    buffer_store_short v141, v159, s[8:11], s20 offen sc1
    s_branch L_sd_67
L_sl_77:
    s_nop 7
    buffer_store_short v141, v159, s[8:11], s20 offen sc1
    s_branch L_sd_78
L_sl_90:
    s_nop 7
    buffer_store_dword v64, v6, s[8:11], s60 offen sc1
    s_branch L_sd_91
L_sl_105:
    s_nop 7
    buffer_store_dword v136, v6, s[8:11], s60 offen sc1
    s_branch L_sd_106
L_sl_117:
    s_nop 7
    buffer_store_dwordx2 v[138:139], v1, s[8:11], s27 offen offset:2048 sc1
    s_branch L_sd_118
L_sl_120:
    s_nop 7
    buffer_store_short v136, v159, s[8:11], s20 offen sc1
    s_branch L_sd_121
L_sl_125:
    s_nop 7
    buffer_store_short v141, v159, s[8:11], s60 offen sc1
    s_branch L_sd_126
L_sl_130:
    s_nop 7
    buffer_store_short v141, v159, s[8:11], s60 offen sc1
    s_branch L_sd_131
.section .rodata,"a"
.p2align 6
.amdhsa_kernel interleave_layers__sliding_block_cached__sliding_block_cached__decode_kernel
  .amdhsa_next_free_vgpr 168
  .amdhsa_next_free_sgpr 102
  .amdhsa_accum_offset 168
  .amdhsa_group_segment_fixed_size 0
  .amdhsa_kernarg_size 104
  .amdhsa_user_sgpr_count 2
  .amdhsa_user_sgpr_kernarg_segment_ptr 1
  .amdhsa_system_sgpr_workgroup_id_x 1
.end_amdhsa_kernel
```
